```python
import torch

def _softmax(x, axis=-1):
    return torch.softmax(x, dim=axis)
def _gelu(x):
    return torch.nn.functional.gelu(x, approximate="tanh")
def _silu(x):
    return torch.nn.functional.silu(x)
def _sigmoid(x):
    return torch.sigmoid(x)
def _layernorm(x, axis=-1, eps=1e-5):
    m = x.mean(dim=axis, keepdim=True)
    v = x.var(dim=axis, keepdim=True, unbiased=False)
    return (x - m) / torch.sqrt(v + eps)
def _scatter_add(tgt, idx, src, axis=0):
    return tgt.clone().index_add_(axis, idx, src)
def _segment_sum(src, seg, n):
    out = torch.zeros((n,) + src.shape[1:], dtype=src.dtype)
    return out.index_add_(0, seg, src)
def _pad(x, pw):
    flat = tuple(v for pair in reversed(pw) for v in pair)
    return torch.nn.functional.pad(x, flat)

kernel_name = 'concat_heads__linear_kernel_hedgehog__ssm_conv_s5__prompt'

def setup_inputs():

    _w = (lambda a: (lambda t: t.to(torch.bfloat16) if t.is_floating_point() else t)(torch.as_tensor(a)))
    def _A_setup():
        B, S, D, H = 1, 2048, 640, 32
        Dh = D // H
        return {
            "x": _w((lambda *s: torch.randn(*s, dtype=torch.bfloat16) * 0.4)(B, S, D)),
            "wqkv": _w((lambda *s: torch.randn(*s, dtype=torch.bfloat16) * 0.4)(D, 3 * D)),
            "w_phi": _w((lambda *s: torch.randn(*s, dtype=torch.bfloat16) * 0.4)(H, Dh, Dh) * (Dh ** -0.5)),
            "wo": _w((lambda *s: torch.randn(*s, dtype=torch.bfloat16) * 0.05)(D, D)),
        }
    _A_in = _A_setup()

    def _B_setup():
        B, S, D = 1, 2048, 640
        P = D
        Lambda_re = -0.5 * (lambda _x: torch.exp(torch.as_tensor(_x)))((lambda *s: torch.randn(*s, dtype=torch.bfloat16) * 0.8)(P))
        Lambda_im = (lambda *s: torch.randn(*s, dtype=torch.bfloat16) * 0.8)(P) * 1.0
        B_re = (lambda *s: torch.randn(*s, dtype=torch.bfloat16) * 0.8)(P, D) * (D ** -0.5)
        B_im = (lambda *s: torch.randn(*s, dtype=torch.bfloat16) * 0.8)(P, D) * (D ** -0.5)
        C_re = (lambda *s: torch.randn(*s, dtype=torch.bfloat16) * 0.8)(D, P) * (P ** -0.5)
        C_im = (lambda *s: torch.randn(*s, dtype=torch.bfloat16) * 0.8)(D, P) * (P ** -0.5)
        log_dt = (lambda *s: torch.randn(*s, dtype=torch.bfloat16) * 0.8)(P) * 0.3 - 2.0
        Dskip = (lambda *s: torch.randn(*s, dtype=torch.bfloat16) * 0.8)(D)
        return {
            "x": _w((lambda *s: torch.randn(*s, dtype=torch.bfloat16) * 0.05)(B, S, D)),
            "Lambda_re": _w(Lambda_re),
            "Lambda_im": _w(Lambda_im),
            "B_re": _w(B_re),
            "B_im": _w(B_im),
            "C_re": _w(C_re),
            "C_im": _w(C_im),
            "log_dt": _w(log_dt),
            "Dskip": _w(Dskip),
        }
    _B_in = _B_setup()

    return {
        "A_x": _A_in["x"],
        "A_wqkv": _A_in["wqkv"],
        "A_w_phi": _A_in["w_phi"],
        "A_wo": _A_in["wo"],
        "B_x": _B_in["x"],
        "B_Lambda_re": _B_in["Lambda_re"],
        "B_Lambda_im": _B_in["Lambda_im"],
        "B_B_re": _B_in["B_re"],
        "B_B_im": _B_in["B_im"],
        "B_C_re": _B_in["C_re"],
        "B_C_im": _B_in["C_im"],
        "B_log_dt": _B_in["log_dt"],
        "B_Dskip": _B_in["Dskip"],
    }

def reference(A_x, A_wqkv, A_w_phi, A_wo, B_x, B_Lambda_re, B_Lambda_im, B_B_re, B_B_im, B_C_re, B_C_im, B_log_dt, B_Dskip):
    def _A_ref(x, wqkv, w_phi, wo):
        B, S, D = x.shape
        H = 32; Dh = D // H
        qkv = (lambda x, *d: x.permute(*d))((x @ wqkv).reshape(B, S, 3, H, Dh), 2, 0, 3, 1, 4)
        q, k, v = qkv[0], qkv[1], qkv[2]
        pq = torch.einsum("bhsd,hdf->bhsf", q, w_phi)
        pk = torch.einsum("bhsd,hdf->bhsf", k, w_phi)
        phi_q = torch.concatenate([_softmax(pq, axis=-1), _softmax(-pq, axis=-1)], axis=-1)
        phi_k = torch.concatenate([_softmax(pk, axis=-1), _softmax(-pk, axis=-1)], axis=-1)
        kv = torch.einsum("bhsf,bhsd->bhfd", phi_k, v)
        z  = torch.einsum("bhsf->bhf", phi_k)
        num = torch.einsum("bhqf,bhfd->bhqd", phi_q, kv)
        den = torch.einsum("bhqf,bhf->bhq", phi_q, z)[..., None] + 1e-6
        o = num / den
        return (lambda x, *d: x.permute(*d))(o, 0, 2, 1, 3).reshape(B, S, D) @ wo

    def _B_ref(x, Lambda_re, Lambda_im, B_re, B_im, C_re, C_im, log_dt, Dskip):
        Bsz, L, H = x.shape
        Lam = Lambda_re + 1j * Lambda_im
        Bmat = B_re + 1j * B_im
        Cmat = C_re + 1j * C_im
        dt = torch.exp(log_dt)
        Lam_bar = torch.exp(dt * Lam)
        B_bar = ((Lam_bar - 1.0) / Lam)[:, None] * Bmat
        Bu = torch.einsum("bld,pd->blp", x + 0j, B_bar)
        h = torch.zeros_like(Bu[:, 0, :])
        hs = []
        for t in range(L):
            h = Lam_bar[None, :] * h + Bu[:, t, :]
            hs.append(h)
        hseq = torch.stack(hs, 1)
        y = 2.0 * torch.einsum("blp,dp->bld", hseq, Cmat).real + x * Dskip[None, None, :]
        return y

    a = _A_ref(A_x, A_wqkv, A_w_phi, A_wo)
    b = _B_ref(B_x, B_Lambda_re, B_Lambda_im, B_B_re, B_B_im, B_C_re, B_C_im, B_log_dt, B_Dskip)
    return torch.concatenate([a, b], axis=-1)
```

```asm
; @launch grid=(256,1,1) block=(512,1,1) lds=163840
.amdgcn_target "amdgcn-amd-amdhsa--gfx950"
.text
.globl concat_heads__linear_kernel_hedgehog__ssm_conv_s5__prompt_kernel
.p2align 8
.type concat_heads__linear_kernel_hedgehog__ssm_conv_s5__prompt_kernel,@function
concat_heads__linear_kernel_hedgehog__ssm_conv_s5__prompt_kernel:
    s_cmp_ge_u32 s2, 256
    s_cbranch_scc1 L_end
    s_load_dwordx16 s[32:47], s[0:1], 0
    s_load_dwordx16 s[48:63], s[0:1], 64
    s_getpc_b64 s[64:65]
    v_lshlrev_b32_e64 v19, 6, v0
    global_load_dword v255, v19, s[64:65]
    v_lshrrev_b32_e64 v19, 2, v19
    v_and_b32 v19, 0x1fc0, v19
    v_add_u32 v19, 32768, v19
    global_load_dword v255, v19, s[64:65]
    v_lshrrev_b32 v18, 6, v0
    v_and_b32 v1, 63, v0
    s_and_b32 s29, s2, 7
    s_lshr_b32 s30, s2, 3
    v_readfirstlane_b32 s3, v18
    s_and_b32 s20, s29, 1
    s_lshl_b32 s20, s20, 2
    s_and_b32 s31, s30, 3
    s_add_u32 s20, s20, s31
    s_lshr_b32 s21, s29, 1
    s_and_b32 s21, s21, 1
    s_lshl_b32 s21, s21, 3
    s_lshr_b32 s31, s30, 2
    s_add_u32 s21, s21, s31
    v_and_b32 v16, 15, v1
    v_lshrrev_b32 v17, 4, v1
    s_mov_b32 s66, 49152
    s_and_b32 s67, s3, 3
    s_mov_b32 s7, 0x20000
    s_mov_b32 s11, 0x20000
    s_mov_b32 s15, 0x20000
    s_mov_b32 s19, 0x20000
    s_mov_b32 s14, 0x10000000
    s_mov_b32 s6, 2621440
    v_mov_b32 v2, 163776
    v_mov_b32 v4, 0
    v_mov_b32 v5, 0
    v_mov_b32 v6, 0
    v_mov_b32_e64 v7, 0
    ds_write_b128 v2, v[4:7]
    ds_write_b128 v2, v[4:7] offset:16
    ds_write_b128 v2, v[4:7] offset:32
    v_mov_b32 v253, 163776
    s_cmp_lt_u32 s3, 4
    s_cbranch_scc1 L_compute
    v_lshrrev_b32_e64 v18, 3, v1
    v_mul_u32_u24 v18, 1280, v18
    v_and_b32_e64 v19, 7, v1
    v_lshl_add_u32 v18, v19, 4, v18
    s_and_b32 s27, s67, 1
    s_lshr_b32 s24, s67, 1
    s_lshl_b32 s22, s20, 8
    s_lshl_b32 s31, s24, 7
    s_add_u32 s22, s22, s31
    s_mul_i32 s22, s22, 1280
    s_lshl_b32 s31, s27, 7
    s_add_u32 s22, s22, s31
    s_lshl_b32 s25, s24, 14
    s_mul_i32 s31, s27, 49152
    s_add_u32 s25, s25, s31
    s_lshl_b32 s31, s27, 3
    s_lshl_b32 s69, s24, 2
    s_add_u32 s31, s31, s69
    v_add_u32 v23, s31, v253
    s_cmp_ge_u32 s29, 4
    s_cbranch_scc1 L_ldB
    v_lshlrev_b32 v19, 4, v17
    v_xor_b32 v2, v18, v19
    v_xor_b32 v3, 64, v2
    v_add_u32 v3, 9216, v3
    v_add_u32 v4, 18432, v2
    v_xor_b32_e64 v5, 64, v2
    v_add_u32 v5, 27648, v5
    v_add_u32 v6, 40960, v2
    v_xor_b32_e64 v7, 64, v2
    v_add_u32 v7, 50176, v7
    v_add_u32 v8, 59392, v2
    v_xor_b32_e64 v9, 64, v2
    v_add_u32 v9, 68608, v9
    v_lshlrev_b32 v18, 1, v17
    v_sub_u32 v18, v16, v18
    v_add_u32 v18, 0, v18
    v_and_b32 v18, 15, v18
    v_mul_u32_u24 v19, 13, v18
    v_lshrrev_b32 v19, 6, v19
    v_mul_u32_u24 v10, 3840, v17
    v_mul_u32_u24 v12, 1200, v19
    v_add_u32_e64 v10, v10, v12
    v_lshl_add_u32 v10, v18, 4, v10
    v_cmp_eq_u32 vcc, 15, v18
    v_mov_b32 v12, 1073741824
    s_nop 0
    v_cndmask_b32 v10, v10, v12, vcc
    v_lshlrev_b32 v18, 1, v17
    v_sub_u32 v18, v16, v18
    v_add_u32 v18, 8, v18
    v_and_b32 v18, 15, v18
    v_mul_u32_u24 v19, 13, v18
    v_lshrrev_b32 v19, 6, v19
    v_mul_u32_u24 v11, 3840, v17
    v_mul_u32_u24 v12, 1200, v19
    v_add_u32_e64 v11, v11, v12
    v_lshl_add_u32 v11, v18, 4, v11
    v_cmp_eq_u32 vcc, 15, v18
    v_mov_b32 v12, 1073741824
    s_nop 0
    v_cndmask_b32 v11, v11, v12, vcc
    s_mul_i32 s23, s24, 122880
    s_mul_i32 s31, s21, 80
    s_add_u32 s23, s23, s31
    s_mul_i32 s31, s27, 245760
    s_add_u32 s23, s23, s31
    s_lshl_b32 s26, s24, 13
    s_add_u32 s26, s26, 32768
    s_mul_i32 s31, s27, 49152
    s_add_u32 s26, s26, s31
    s_mov_b32 s10, 2457600
    s_waitcnt lgkmcnt(0)
    s_barrier
    s_mov_b32 s4, s32
    s_mov_b32 s5, s33
    s_mov_b32 s8, s34
    s_mov_b32 s9, s35
    s_cmp_eq_u32 s27, 0
    s_cbranch_scc1 L_g1_1_x
    L_g1_1:
    ds_read_b32 v24, v253 offset:36
    s_waitcnt lgkmcnt(0)
    v_readfirstlane_b32 s31, v24
    s_nop 3
    s_cmp_eq_u32 s31, 0
    s_cbranch_scc1 L_g1_1
    L_g1_1_x:
    s_add_u32 m0, s25, 0
    s_nop 0
    buffer_load_dwordx4 v2, s[4:7], s22 offen offset:0 lds
    buffer_load_dwordx4 v3, s[4:7], s22 offen offset:1024 lds
    buffer_load_dwordx4 v4, s[4:7], s22 offen offset:2048 lds
    buffer_load_dwordx4 v5, s[4:7], s22 offen offset:3072 lds
    s_add_u32 m0, s25, 4096
    s_nop 0
    buffer_load_dwordx4 v6, s[4:7], s22 offen offset:0 lds
    buffer_load_dwordx4 v7, s[4:7], s22 offen offset:1024 lds
    buffer_load_dwordx4 v8, s[4:7], s22 offen offset:2048 lds
    buffer_load_dwordx4 v9, s[4:7], s22 offen offset:3072 lds
    s_add_u32 s31, s22, 81920
    s_add_u32 m0, s25, 8192
    s_nop 0
    buffer_load_dwordx4 v2, s[4:7], s31 offen offset:0 lds
    buffer_load_dwordx4 v3, s[4:7], s31 offen offset:1024 lds
    buffer_load_dwordx4 v4, s[4:7], s31 offen offset:2048 lds
    buffer_load_dwordx4 v5, s[4:7], s31 offen offset:3072 lds
    s_add_u32 m0, s25, 12288
    s_nop 0
    buffer_load_dwordx4 v6, s[4:7], s31 offen offset:0 lds
    buffer_load_dwordx4 v7, s[4:7], s31 offen offset:1024 lds
    buffer_load_dwordx4 v8, s[4:7], s31 offen offset:2048 lds
    buffer_load_dwordx4 v9, s[4:7], s31 offen offset:3072 lds
    s_add_u32 m0, s26, 0
    s_add_u32 s31, s23, 0
    buffer_load_dwordx4 v10, s[8:11], s31 offen offset:0 lds
    s_add_u32 s31, s23, 14336
    buffer_load_dwordx4 v10, s[8:11], s31 offen offset:1024 lds
    s_add_u32 s31, s23, 28672
    buffer_load_dwordx4 v11, s[8:11], s31 offen offset:2048 lds
    s_add_u32 s31, s23, 43008
    buffer_load_dwordx4 v11, s[8:11], s31 offen offset:3072 lds
    s_add_u32 m0, s26, 4096
    s_add_u32 s31, s23, 61440
    buffer_load_dwordx4 v10, s[8:11], s31 offen offset:0 lds
    s_add_u32 s31, s23, 75776
    buffer_load_dwordx4 v10, s[8:11], s31 offen offset:1024 lds
    s_add_u32 s31, s23, 90112
    buffer_load_dwordx4 v11, s[8:11], s31 offen offset:2048 lds
    s_add_u32 s31, s23, 104448
    buffer_load_dwordx4 v11, s[8:11], s31 offen offset:3072 lds
    s_add_u32 s22, s22, 256
    s_add_u32 s23, s23, 491520
    s_add_u32 s25, s25, 98304
    s_add_u32 s26, s26, 98304
    s_cmp_ge_u32 s25, 147456
    s_cselect_b32 s31, 147456, 0
    s_sub_u32 s25, s25, s31
    s_sub_u32 s26, s26, s31
    v_mov_b32_e64 v24, 1
    ds_write_b32 v253, v24 offset:36
    s_load_dwordx2 s[70:71], s[62:63], 0
    s_mov_b32 s12, s62
    s_mov_b32 s13, s63
    v_mov_b32_e64 v18, 1073741824
    v_mul_u32_u24 v29, 1280, v1
    v_cmp_lt_u32 vcc, 15, v1
    s_lshl_b32 s79, s20, 8
    s_lshr_b32 s31, s30, 2
    s_lshl_b32 s31, s31, 5
    s_add_u32 s79, s79, s31
    s_lshl_b32 s31, s24, 4
    s_add_u32 s79, s79, s31
    s_mul_i32 s79, s79, 1280
    s_lshl_b32 s31, s27, 7
    s_add_u32 s79, s79, s31
    s_add_u32 s79, s79, 256
    v_cndmask_b32 v29, v29, v18, vcc
    v_mul_u32_u24 v19, 13, v1
    v_lshrrev_b32 v19, 6, v19
    v_mul_u32_u24 v19, 640, v19
    v_lshl_add_u32 v28, v1, 7, v19
    v_cmp_lt_u32 vcc, 14, v1
    s_lshl_b32 s65, s30, 1
    s_add_u32 s65, s65, s24
    s_lshl_b32 s31, s27, 6
    s_add_u32 s65, s65, s31
    s_add_u32 s65, s65, 128
    s_mul_i32 s65, s65, 3840
    s_lshr_b32 s31, s29, 1
    s_mul_i32 s31, s31, 640
    s_add_u32 s65, s65, s31
    v_cndmask_b32 v28, v28, v18, vcc
    buffer_load_dword v254, v28, s[8:11], s65 offen
    s_add_u32 s65, s65, 491520
    buffer_load_dword v254, v29, s[4:7], s79 offen
    s_add_u32 s79, s79, 256
    s_waitcnt lgkmcnt(0)
    s_add_u32 s72, s70, 1
    s_addc_u32 s73, s71, 0
    s_add_u32 s69, s27, 1
    v_mov_b32 v24, s69
    s_waitcnt vmcnt(2)
    ds_write_b32 v23, v24
    s_add_u32 s27, s27, 2
L_lloopA:
    s_sub_u32 s68, s27, 2
L_wf_2:
    ds_read_b128 v[24:27], v253 offset:16
    s_waitcnt lgkmcnt(0)
    v_min3_i32 v24, v24, v25, v26
    v_min_i32 v24, v24, v27
    s_nop 0
    v_readfirstlane_b32 s31, v24
    s_nop 3
    s_cmp_ge_i32 s31, s68
    s_cbranch_scc1 L_wf_3
    s_sleep 1
    s_branch L_wf_2
L_wf_3:
    s_add_u32 m0, s25, 0
    s_nop 0
    buffer_load_dwordx4 v2, s[4:7], s22 offen offset:0 lds
    buffer_load_dwordx4 v3, s[4:7], s22 offen offset:1024 lds
    buffer_load_dwordx4 v4, s[4:7], s22 offen offset:2048 lds
    buffer_load_dwordx4 v5, s[4:7], s22 offen offset:3072 lds
    s_add_u32 m0, s25, 4096
    s_nop 0
    buffer_load_dwordx4 v6, s[4:7], s22 offen offset:0 lds
    buffer_load_dwordx4 v7, s[4:7], s22 offen offset:1024 lds
    buffer_load_dwordx4 v8, s[4:7], s22 offen offset:2048 lds
    buffer_load_dwordx4 v9, s[4:7], s22 offen offset:3072 lds
    s_add_u32 s31, s22, 81920
    s_add_u32 m0, s25, 8192
    s_nop 0
    buffer_load_dwordx4 v2, s[4:7], s31 offen offset:0 lds
    buffer_load_dwordx4 v3, s[4:7], s31 offen offset:1024 lds
    buffer_load_dwordx4 v4, s[4:7], s31 offen offset:2048 lds
    buffer_load_dwordx4 v5, s[4:7], s31 offen offset:3072 lds
    s_add_u32 m0, s25, 12288
    s_nop 0
    buffer_load_dwordx4 v6, s[4:7], s31 offen offset:0 lds
    buffer_load_dwordx4 v7, s[4:7], s31 offen offset:1024 lds
    buffer_load_dwordx4 v8, s[4:7], s31 offen offset:2048 lds
    buffer_load_dwordx4 v9, s[4:7], s31 offen offset:3072 lds
    s_add_u32 m0, s26, 0
    s_add_u32 s31, s23, 0
    buffer_load_dwordx4 v10, s[8:11], s31 offen offset:0 lds
    s_add_u32 s31, s23, 14336
    buffer_load_dwordx4 v10, s[8:11], s31 offen offset:1024 lds
    s_add_u32 s31, s23, 28672
    buffer_load_dwordx4 v11, s[8:11], s31 offen offset:2048 lds
    s_add_u32 s31, s23, 43008
    buffer_load_dwordx4 v11, s[8:11], s31 offen offset:3072 lds
    s_add_u32 m0, s26, 4096
    s_add_u32 s31, s23, 61440
    buffer_load_dwordx4 v10, s[8:11], s31 offen offset:0 lds
    s_add_u32 s31, s23, 75776
    buffer_load_dwordx4 v10, s[8:11], s31 offen offset:1024 lds
    s_add_u32 s31, s23, 90112
    buffer_load_dwordx4 v11, s[8:11], s31 offen offset:2048 lds
    s_add_u32 s31, s23, 104448
    buffer_load_dwordx4 v11, s[8:11], s31 offen offset:3072 lds
    s_add_u32 s22, s22, 256
    s_add_u32 s23, s23, 491520
    s_add_u32 s25, s25, 98304
    s_add_u32 s26, s26, 98304
    s_cmp_ge_u32 s25, 147456
    s_cselect_b32 s31, 147456, 0
    s_sub_u32 s25, s25, s31
    s_sub_u32 s26, s26, s31
    s_cmp_lt_u32 s27, 8
    s_cselect_b32 s79, s79, 1073741824
    buffer_load_dword v254, v28, s[8:11], s65 offen
    s_add_u32 s65, s65, 491520
    buffer_load_dword v254, v29, s[4:7], s79 offen
    s_add_u32 s79, s79, 256
    s_add_u32 s69, s27, 1
    v_mov_b32 v24, s69
    s_waitcnt vmcnt(2)
    ds_write_b32 v23, v24
    s_add_u32 s27, s27, 2
    s_cmp_lt_u32 s27, 10
    s_cbranch_scc1 L_lloopA
    s_mov_b32 s16, s38
    s_mov_b32 s17, s39
    s_mov_b32 s18, 819200
    s_mov_b32 s68, s67
    s_lshl_b32 s31, s30, 2
    s_add_u32 s31, s31, s68
    s_mul_i32 s31, s31, 6400
    v_lshlrev_b32 v18, 7, v1
    v_cmp_gt_u32 vcc, 50, v1
    v_mov_b32 v19, 1073741824
    s_nop 0
    v_cndmask_b32 v18, v19, v18, vcc
    buffer_load_dword v254, v18, s[16:19], s31 offen
    s_add_u32 s31, s31, 6400
    v_mov_b32 v14, 0
    v_mov_b32 v15, 1
    v_mov_b32 v105, 0
    s_cmp_eq_u32 s67, 1
    s_cbranch_scc0 L_at_4
    s_mov_b64 exec, 1
    global_atomic_add v105, v14, v15, s[60:61] sc0 sc1
    s_mov_b64 exec, -1
L_at_4:
    s_mov_b32 s64, 2
    s_mul_i32 s31, s67, 5120
    s_add_u32 s31, s31, 32768
    v_lshlrev_b32 v220, 4, v1
    v_add_u32 v220, s31, v220
    v_bfe_u32 v249, v1, 2, 2
    v_and_b32 v250, 3, v1
    v_and_b32 v251, 1, v17
    v_mul_u32_u24_e64 v14, 40, v249
    v_mul_u32_u24 v15, 800, v251
    v_add_u32_e64 v14, v14, v15
    v_add_u32 v14, 147456, v14
    v_cmp_eq_u32 vcc, v250, v17
    v_lshlrev_b32 v15, 3, v1
    v_add_u32 v15, 149120, v15
    v_cndmask_b32 v221, v15, v14, vcc
    v_lshrrev_b32 v252, 1, v17
    v_lshl_add_u32 v14, v252, 4, v16
    s_lshl_b32 s31, s67, 6
    s_lshl_b32 s68, s64, 4
    s_add_u32 s31, s31, s68
    v_add_u32 v14, s31, v14
    v_lshlrev_b32_e64 v14, 8, v14
    v_add_u32 v14, 65536, v14
    v_and_b32 v15, 3, v16
    v_lshrrev_b32 v18, 3, v16
    v_lshl_add_u32 v15, v18, 2, v15
    v_mul_u32_u24 v18, 3, v251
    v_add_u32 v19, 0, v18
    v_xor_b32_e64 v19, v19, v15
    v_lshl_add_u32 v222, v19, 5, v14
    v_add_u32 v19, 1, v18
    v_xor_b32 v19, v19, v15
    v_lshl_add_u32 v223, v19, 5, v14
    v_add_u32 v19, 2, v18
    v_xor_b32 v19, v19, v15
    v_lshl_add_u32 v224, v19, 5, v14
    s_lshr_b32 s31, s3, 2
    s_mul_i32 s69, s31, 3
    s_add_u32 s69, s69, s67
    s_lshl_b32 s68, s31, 3
    v_lshl_add_u32 v14, v17, 3, v249
    v_lshl_add_u32 v15, v251, 2, v249
    v_xor_b32 v15, s69, v15
    v_lshlrev_b32 v15, 5, v15
    v_lshl_add_u32 v15, v14, 8, v15
    v_lshl_add_u32 v229, v250, 3, v15
    v_add_u32 v229, 65536, v229
    v_and_b32 v15, 1, v249
    v_lshrrev_b32 v18, 1, v249
    v_lshl_add_u32 v15, v18, 2, v15
    v_lshl_add_u32 v15, v251, 3, v15
    v_add_u32 v18, s68, v250
    v_xor_b32 v15, v15, v18
    v_lshlrev_b32 v14, 7, v14
    v_add_u32 v14, 0, v14
    v_xor_b32_e64 v18, 0, v15
    v_lshl_add_u32 v230, v18, 3, v14
    v_xor_b32_e64 v18, 2, v15
    v_lshl_add_u32 v231, v18, 3, v14
    v_xor_b32_e64 v18, 4, v15
    v_lshl_add_u32 v232, v18, 3, v14
    v_xor_b32_e64 v18, 6, v15
    v_lshl_add_u32 v233, v18, 3, v14
    s_mul_i32 s31, s31, 210
    s_lshl_b32 s68, s67, 2
    s_add_u32 s31, s31, s68
    v_mul_u32_u24 v14, 10, v16
    v_add_u32 v14, v14, v17
    v_add_u32 v14, s31, v14
    v_lshlrev_b32 v14, 4, v14
    v_add_u32 v15, s68, v17
    v_cmp_lt_u32 vcc, 9, v15
    v_mov_b32 v19, 1073741824
    s_nop 0
    v_cndmask_b32_e64 v234, v14, v19, vcc
    v_add_u32 v14, 2560, v234
    v_cmp_lt_u32 vcc, 4, v16
    s_nop 1
    v_cndmask_b32 v235, v14, v19, vcc
    v_lshrrev_b32 v14, 2, v16
    v_and_b32_e64 v15, 1, v14
    v_cmp_eq_u32 s[74:75], v251, v15
    v_lshrrev_b32 v14, 1, v14
    v_mul_u32_u24 v14, 10, v14
    v_and_b32 v15, 3, v16
    v_add_u32 v14, v14, v15
    v_mul_u32_u24 v18, 2016, v251
    v_mul_u32_u24 v19, 48, v252
    v_add_u32 v18, v18, v19
    v_add_u32 v18, 150400, v18
    v_lshlrev_b32_e64 v19, 4, v1
    v_add_u32 v19, 149120, v19
    v_add_u32_e64 v249, 0, v14
    v_mul_u32_u24 v249, 96, v249
    v_add_u32_e64 v249, v249, v18
    v_cndmask_b32 v240, v19, v249, s[74:75]
    v_add_u32_e64 v249, 4, v14
    v_mul_u32_u24 v249, 96, v249
    v_add_u32_e64 v249, v249, v18
    v_cndmask_b32 v241, v19, v249, s[74:75]
    v_add_u32 v249, 8, v14
    v_cmp_lt_u32 vcc, 1, v15
    v_mov_b32 v250, 20
    s_nop 0
    v_cndmask_b32_e64 v249, v249, v250, vcc
    v_mul_u32_u24 v249, 96, v249
    v_add_u32_e64 v249, v249, v18
    v_cndmask_b32 v242, v19, v249, s[74:75]
    s_mul_i32 s31, s67, 5120
    s_add_u32 s31, s31, 126976
    v_mul_u32_u24 v14, 80, v16
    v_add_u32 v14, s31, v14
    v_mul_u32_u24 v15, 40, v251
    v_mul_u32_u24_e64 v18, 20, v252
    v_add3_u32 v243, v15, v18, v14
    v_add_u32 v244, 1280, v243
    v_lshl_add_u32 v245, v17, 4, v14
    v_mul_u32_u24 v15, 1280, v251
    v_add_u32 v246, v15, v14
    v_lshlrev_b32 v14, 4, v16
    v_lshl_add_u32 v247, v17, 8, v14
    v_mul_u32_u24 v15, 20480, v251
    v_add_u32_e64 v248, v15, v14
    ds_read_b64_tr_b16 v[30:31], v221 offset:0
    ds_read_b64_tr_b16 v[32:33], v221 offset:160
    ds_read_b64_tr_b16 v[34:35], v221 offset:320
    ds_read_b64_tr_b16 v[36:37], v221 offset:480
    ds_read_b64_tr_b16 v[38:39], v221 offset:640
    ds_read_b64_tr_b16 v[40:41], v221 offset:8
    ds_read_b64_tr_b16 v[42:43], v221 offset:168
    ds_read_b64_tr_b16 v[44:45], v221 offset:328
    ds_read_b64_tr_b16 v[46:47], v221 offset:488
    ds_read_b64_tr_b16 v[48:49], v221 offset:648
    ds_read_b64_tr_b16 v[50:51], v221 offset:16
    ds_read_b64_tr_b16 v[52:53], v221 offset:176
    ds_read_b64_tr_b16 v[54:55], v221 offset:336
    ds_read_b64_tr_b16 v[56:57], v221 offset:496
    ds_read_b64_tr_b16 v[58:59], v221 offset:656
    ds_read_b64_tr_b16 v[60:61], v221 offset:24
    ds_read_b64_tr_b16 v[62:63], v221 offset:184
    ds_read_b64_tr_b16 v[64:65], v221 offset:344
    ds_read_b64_tr_b16 v[66:67], v221 offset:504
    ds_read_b64_tr_b16 v[68:69], v221 offset:664
    ds_read_b64_tr_b16 v[70:71], v221 offset:32
    ds_read_b64_tr_b16 v[72:73], v221 offset:192
    ds_read_b64_tr_b16 v[74:75], v221 offset:352
    ds_read_b64_tr_b16 v[76:77], v221 offset:512
    ds_read_b64_tr_b16 v[78:79], v221 offset:672
    s_mov_b32 s69, 6554
    v_mov_b32 v236, 1073741824
    v_mov_b32 v237, 1073741824
    v_add_u32 v18, 0, v1
    v_mul_u32_u24 v19, s69, v18
    v_lshrrev_b32 v19, 16, v19
    v_mul_u32_u24 v20, 10, v19
    v_sub_u32 v18, v18, v20
    v_lshrrev_b32 v20, 1, v19
    v_xor_b32 v20, v20, v19
    v_and_b32 v20, 4, v20
    v_mul_u32_u24 v20, 3, v20
    v_xor_b32 v19, v19, v20
    v_mul_u32_u24 v19, 1280, v19
    v_lshl_add_u32 v100, v18, 4, v19
    v_add_u32 v18, 64, v1
    v_mul_u32_u24 v19, s69, v18
    v_lshrrev_b32 v19, 16, v19
    v_mul_u32_u24 v20, 10, v19
    v_sub_u32 v18, v18, v20
    v_lshrrev_b32 v20, 1, v19
    v_xor_b32 v20, v20, v19
    v_and_b32 v20, 4, v20
    v_mul_u32_u24 v20, 3, v20
    v_xor_b32 v19, v19, v20
    v_mul_u32_u24 v19, 1280, v19
    v_lshl_add_u32 v101, v18, 4, v19
    v_add_u32 v18, 128, v1
    v_mul_u32_u24 v19, s69, v18
    v_lshrrev_b32 v19, 16, v19
    v_mul_u32_u24 v20, 10, v19
    v_sub_u32 v18, v18, v20
    v_lshrrev_b32 v20, 1, v19
    v_xor_b32 v20, v20, v19
    v_and_b32 v20, 4, v20
    v_mul_u32_u24 v20, 3, v20
    v_xor_b32_e64 v19, v19, v20
    v_mul_u32_u24 v19, 1280, v19
    v_lshl_add_u32 v102, v18, 4, v19
    v_add_u32 v18, 192, v1
    v_mul_u32_u24 v19, s69, v18
    v_lshrrev_b32 v19, 16, v19
    v_mul_u32_u24 v20, 10, v19
    v_sub_u32 v18, v18, v20
    v_lshrrev_b32 v20, 1, v19
    v_xor_b32 v20, v20, v19
    v_and_b32 v20, 4, v20
    v_mul_u32_u24 v20, 3, v20
    v_xor_b32_e64 v19, v19, v20
    v_mul_u32_u24 v19, 1280, v19
    v_lshl_add_u32 v103, v18, 4, v19
    v_add_u32 v18, 256, v1
    v_mul_u32_u24 v19, s69, v18
    v_lshrrev_b32 v19, 16, v19
    v_mul_u32_u24 v20, 10, v19
    v_sub_u32 v18, v18, v20
    v_lshrrev_b32 v20, 1, v19
    v_xor_b32 v20, v20, v19
    v_and_b32 v20, 4, v20
    v_mul_u32_u24 v20, 3, v20
    v_xor_b32_e64 v19, v19, v20
    v_mul_u32_u24 v19, 1280, v19
    v_lshl_add_u32 v104, v18, 4, v19
    s_branch L_A_helper
L_ldB:
    v_mov_b32 v2, v18
    v_xor_b32_e64 v3, 16, v2
    v_add_u32 v3, 9216, v3
    v_xor_b32_e64 v4, 32, v2
    v_add_u32 v4, 18432, v4
    v_xor_b32_e64 v5, 48, v2
    v_add_u32 v5, 27648, v5
    v_xor_b32_e64 v6, 64, v2
    v_add_u32 v6, 40960, v6
    v_xor_b32 v7, 80, v2
    v_add_u32 v7, 50176, v7
    v_xor_b32 v8, 96, v2
    v_add_u32 v8, 59392, v8
    v_xor_b32 v9, 112, v2
    v_add_u32 v9, 68608, v9
    v_lshlrev_b32 v19, 4, v17
    v_xor_b32 v10, v18, v19
    s_lshl_b32 s31, s24, 6
    v_xor_b32 v10, s31, v10
    v_xor_b32_e64 v11, 64, v10
    v_add_u32 v11, 9216, v11
    v_add_u32 v12, 18432, v10
    v_add_u32 v13, 18432, v11
    s_mul_i32 s23, s21, 51200
    s_lshl_b32 s31, s27, 7
    s_add_u32 s23, s23, s31
    s_mul_i32 s26, s24, 5120
    s_add_u32 s26, s26, 32768
    s_mul_i32 s31, s27, 49152
    s_add_u32 s26, s26, s31
    s_mov_b32 s10, 819200
    s_waitcnt lgkmcnt(0)
    s_barrier
    s_mov_b32 s4, s40
    s_mov_b32 s5, s41
    s_cmp_eq_u32 s24, 0
    s_cselect_b32 s8, s46, s48
    s_cselect_b32 s9, s47, s49
    v_and_b32 v18, 7, v1
    v_add_u32 v18, 32, v18
    v_cmp_gt_u32 vcc, 32, v1
    s_mul_i32 s31, s21, 40
    v_cndmask_b32 v18, v18, v1, vcc
    v_add_u32 v18, s31, v18
    v_lshlrev_b32_e64 v18, 1, v18
    global_load_ushort v32, v18, s[42:43]
    global_load_ushort v33, v18, s[44:45]
    global_load_ushort v34, v18, s[54:55]
    s_cmp_eq_u32 s27, 0
    s_cbranch_scc1 L_g1_5_x
    L_g1_5:
    ds_read_b32 v24, v253 offset:36
    s_waitcnt lgkmcnt(0)
    v_readfirstlane_b32 s31, v24
    s_nop 3
    s_cmp_eq_u32 s31, 0
    s_cbranch_scc1 L_g1_5
    L_g1_5_x:
    s_mov_b32 m0, s26
    s_add_u32 s31, s23, 40960
    buffer_load_dwordx4 v10, s[8:11], s23 offen offset:0 lds
    buffer_load_dwordx4 v11, s[8:11], s23 offen offset:1024 lds
    buffer_load_dwordx4 v12, s[8:11], s23 offen offset:2048 lds
    buffer_load_dwordx4 v13, s[8:11], s23 offen offset:3072 lds
    s_add_u32 m0, s26, 4096
    s_nop 0
    buffer_load_dwordx4 v10, s[8:11], s31 offen lds
    s_add_u32 m0, s25, 0
    s_nop 0
    buffer_load_dwordx4 v2, s[4:7], s22 offen offset:0 lds
    buffer_load_dwordx4 v3, s[4:7], s22 offen offset:1024 lds
    buffer_load_dwordx4 v4, s[4:7], s22 offen offset:2048 lds
    buffer_load_dwordx4 v5, s[4:7], s22 offen offset:3072 lds
    s_add_u32 m0, s25, 4096
    s_nop 0
    buffer_load_dwordx4 v6, s[4:7], s22 offen offset:0 lds
    buffer_load_dwordx4 v7, s[4:7], s22 offen offset:1024 lds
    buffer_load_dwordx4 v8, s[4:7], s22 offen offset:2048 lds
    buffer_load_dwordx4 v9, s[4:7], s22 offen offset:3072 lds
    s_add_u32 s31, s22, 81920
    s_add_u32 m0, s25, 8192
    s_nop 0
    buffer_load_dwordx4 v2, s[4:7], s31 offen offset:0 lds
    buffer_load_dwordx4 v3, s[4:7], s31 offen offset:1024 lds
    buffer_load_dwordx4 v4, s[4:7], s31 offen offset:2048 lds
    buffer_load_dwordx4 v5, s[4:7], s31 offen offset:3072 lds
    s_add_u32 m0, s25, 12288
    s_nop 0
    buffer_load_dwordx4 v6, s[4:7], s31 offen offset:0 lds
    buffer_load_dwordx4 v7, s[4:7], s31 offen offset:1024 lds
    buffer_load_dwordx4 v8, s[4:7], s31 offen offset:2048 lds
    buffer_load_dwordx4 v9, s[4:7], s31 offen offset:3072 lds
    s_add_u32 s22, s22, 256
    s_add_u32 s23, s23, 256
    s_add_u32 s25, s25, 98304
    s_add_u32 s26, s26, 98304
    s_cmp_ge_u32 s25, 147456
    s_cselect_b32 s31, 147456, 0
    s_sub_u32 s25, s25, s31
    s_sub_u32 s26, s26, s31
    v_mov_b32_e64 v24, 1
    ds_write_b32 v253, v24 offset:36
    s_load_dwordx2 s[70:71], s[62:63], 0
    s_mov_b32 s12, s62
    s_mov_b32 s13, s63
    v_mov_b32_e64 v18, 1073741824
    v_mul_u32_u24 v29, 1280, v1
    v_cmp_lt_u32 vcc, 15, v1
    s_lshl_b32 s79, s20, 8
    s_lshr_b32 s31, s30, 2
    s_lshl_b32 s31, s31, 5
    s_add_u32 s79, s79, s31
    s_lshl_b32 s31, s24, 4
    s_add_u32 s79, s79, s31
    s_mul_i32 s79, s79, 1280
    s_lshl_b32 s31, s27, 7
    s_add_u32 s79, s79, s31
    s_add_u32 s79, s79, 256
    v_mov_b32 v28, v29
    v_cndmask_b32_e64 v29, v29, v18, vcc
    v_cmp_lt_u32 vcc, 9, v1
    s_mul_i32 s65, s30, 10
    s_lshr_b32 s31, s29, 1
    s_and_b32 s31, s31, 1
    s_mul_i32 s31, s31, 320
    s_add_u32 s65, s65, s31
    s_mul_i32 s65, s65, 1280
    s_lshl_b32 s31, s27, 7
    s_add_u32 s65, s65, s31
    s_add_u32 s65, s65, 256
    v_cndmask_b32 v28, v28, v18, vcc
    buffer_load_dword v254, v28, s[8:11], s65 offen
    s_add_u32 s65, s65, 256
    buffer_load_dword v254, v29, s[4:7], s79 offen
    s_add_u32 s79, s79, 256
    s_waitcnt lgkmcnt(0)
    s_add_u32 s72, s70, 1
    s_addc_u32 s73, s71, 0
    s_add_u32 s69, s27, 1
    v_mov_b32 v24, s69
    s_waitcnt vmcnt(2)
    ds_write_b32 v23, v24
    s_add_u32 s27, s27, 2
L_lloopB:
    s_sub_u32 s68, s27, 2
L_wf_6:
    ds_read_b128 v[24:27], v253 offset:16
    s_waitcnt lgkmcnt(0)
    v_min3_i32 v24, v24, v25, v26
    v_min_i32 v24, v24, v27
    s_nop 0
    v_readfirstlane_b32 s31, v24
    s_nop 3
    s_cmp_ge_i32 s31, s68
    s_cbranch_scc1 L_wf_7
    s_sleep 1
    s_branch L_wf_6
L_wf_7:
    s_mov_b32 m0, s26
    s_add_u32 s31, s23, 40960
    buffer_load_dwordx4 v10, s[8:11], s23 offen offset:0 lds
    buffer_load_dwordx4 v11, s[8:11], s23 offen offset:1024 lds
    buffer_load_dwordx4 v12, s[8:11], s23 offen offset:2048 lds
    buffer_load_dwordx4 v13, s[8:11], s23 offen offset:3072 lds
    s_add_u32 m0, s26, 4096
    s_nop 0
    buffer_load_dwordx4 v10, s[8:11], s31 offen lds
    s_add_u32 m0, s25, 0
    s_nop 0
    buffer_load_dwordx4 v2, s[4:7], s22 offen offset:0 lds
    buffer_load_dwordx4 v3, s[4:7], s22 offen offset:1024 lds
    buffer_load_dwordx4 v4, s[4:7], s22 offen offset:2048 lds
    buffer_load_dwordx4 v5, s[4:7], s22 offen offset:3072 lds
    s_add_u32 m0, s25, 4096
    s_nop 0
    buffer_load_dwordx4 v6, s[4:7], s22 offen offset:0 lds
    buffer_load_dwordx4 v7, s[4:7], s22 offen offset:1024 lds
    buffer_load_dwordx4 v8, s[4:7], s22 offen offset:2048 lds
    buffer_load_dwordx4 v9, s[4:7], s22 offen offset:3072 lds
    s_add_u32 s31, s22, 81920
    s_add_u32 m0, s25, 8192
    s_nop 0
    buffer_load_dwordx4 v2, s[4:7], s31 offen offset:0 lds
    buffer_load_dwordx4 v3, s[4:7], s31 offen offset:1024 lds
    buffer_load_dwordx4 v4, s[4:7], s31 offen offset:2048 lds
    buffer_load_dwordx4 v5, s[4:7], s31 offen offset:3072 lds
    s_add_u32 m0, s25, 12288
    s_nop 0
    buffer_load_dwordx4 v6, s[4:7], s31 offen offset:0 lds
    buffer_load_dwordx4 v7, s[4:7], s31 offen offset:1024 lds
    buffer_load_dwordx4 v8, s[4:7], s31 offen offset:2048 lds
    buffer_load_dwordx4 v9, s[4:7], s31 offen offset:3072 lds
    s_add_u32 s22, s22, 256
    s_add_u32 s23, s23, 256
    s_add_u32 s25, s25, 98304
    s_add_u32 s26, s26, 98304
    s_cmp_ge_u32 s25, 147456
    s_cselect_b32 s31, 147456, 0
    s_sub_u32 s25, s25, s31
    s_sub_u32 s26, s26, s31
    s_cmp_lt_u32 s27, 8
    s_cselect_b32 s79, s79, 1073741824
    s_cselect_b32 s65, s65, 1073741824
    buffer_load_dword v254, v28, s[8:11], s65 offen
    s_add_u32 s65, s65, 256
    buffer_load_dword v254, v29, s[4:7], s79 offen
    s_add_u32 s79, s79, 256
    s_add_u32 s69, s27, 1
    v_mov_b32 v24, s69
    s_waitcnt vmcnt(2)
    ds_write_b32 v23, v24
    s_add_u32 s27, s27, 2
    s_cmp_lt_u32 s27, 10
    s_cbranch_scc1 L_lloopB
    s_cmp_lt_u32 s67, 2
    s_cselect_b32 s16, s50, s52
    s_cselect_b32 s17, s51, s53
    s_mov_b32 s18, 819200
    s_and_b32 s68, s67, 1
    s_lshl_b32 s68, s68, 1
    s_lshl_b32 s31, s30, 2
    s_add_u32 s31, s31, s68
    s_mul_i32 s31, s31, 6400
    v_lshlrev_b32 v18, 7, v1
    v_cmp_gt_u32 vcc, 50, v1
    v_mov_b32 v19, 1073741824
    s_nop 0
    v_cndmask_b32_e64 v18, v19, v18, vcc
    buffer_load_dword v254, v18, s[16:19], s31 offen
    s_add_u32 s31, s31, 6400
    buffer_load_dword v254, v18, s[16:19], s31 offen
    s_add_u32 s31, s31, 6400
    v_mov_b32 v14, 0
    v_mov_b32 v15, 1
    v_mov_b32 v105, 0
    s_cmp_eq_u32 s67, 1
    s_cbranch_scc0 L_at_8
    s_mov_b64 exec, 1
    global_atomic_add v105, v14, v15, s[60:61] sc0 sc1
    s_mov_b64 exec, -1
L_at_8:
    v_lshlrev_b32 v32, 16, v32
    v_lshlrev_b32_e64 v33, 16, v33
    v_lshlrev_b32 v34, 16, v34
    v_cmp_lt_u32 vcc, 39, v1
    v_xor_b32 v35, 0x80000000, v33
    s_nop 0
    v_cndmask_b32 v33, v33, v35, vcc
    v_mul_f32 v34, 0x3fb8aa3b, v34
    v_exp_f32 v34, v34
    s_nop 0
    v_cvt_pk_bf16_f32 v34, v34, v34
    v_and_b32 v34, 0xffff0000, v34
    v_mul_f32 v32, v34, v32
    v_mul_f32 v33, v34, v33
    v_mul_f32 v32, 0x3fb8aa3b, v32
    v_mul_f32_e64 v33, 0x3e22f983, v33
    v_mul_f32 v32, 0x43800000, v32
    v_mul_f32 v33, 0x43800000, v33
    v_exp_f32 v32, v32
    v_fract_f32 v33, v33
    s_nop 0
    v_cos_f32 v30, v33
    v_sin_f32 v31, v33
    s_nop 0
    v_mul_f32 v30, v30, v32
    v_mul_f32 v31, v31, v32
    s_branch L_B_helper
L_compute:
    s_waitcnt lgkmcnt(0)
    s_barrier
    s_load_dwordx2 s[70:71], s[62:63], 0
    s_mov_b32 s12, s62
    s_mov_b32 s13, s63
    s_cmp_ge_u32 s29, 4
    s_cbranch_scc1 L_B
    v_lshlrev_b32 v3, 7, v16
    s_lshl_b32 s31, s3, 13
    v_add_u32 v3, s31, v3
    v_lshrrev_b32 v2, 1, v16
    v_xor_b32 v2, v2, v17
    v_lshl_add_u32 v8, v2, 4, v3
    v_xor_b32_e64 v2, 4, v2
    v_lshl_add_u32 v9, v2, 4, v3
    s_mov_b32 s16, s36
    s_mov_b32 s17, s37
    s_mov_b32 s18, 25600
    s_cmp_lt_u32 s3, 2
    s_cbranch_scc0 L_wp_9
    v_lshlrev_b32_e64 v2, 4, v0
    s_mul_i32 s31, s21, 1600
    v_add_u32 v3, 147456, v2
    v_cmp_gt_u32 vcc, 1600, v2
    s_and_saveexec_b64 s[76:77], vcc
    buffer_load_dwordx4 v[4:7], v2, s[16:19], s31 offen
    s_mov_b64 exec, s[76:77]
    s_branch L_wz_10
L_wp_9:
    v_lshlrev_b32 v2, 4, v0
    v_add_u32 v2, 147072, v2
    v_mov_b32 v4, 0
    v_mov_b32 v5, 0
    v_mov_b32 v6, 0
    v_mov_b32 v7, 0
    v_cmp_gt_u32 vcc, 208, v0
    s_and_saveexec_b64 s[76:77], vcc
    ds_write_b128 v2, v[4:7]
    s_mov_b64 exec, s[76:77]
L_wz_10:
    v_bfe_u32 v19, v1, 2, 2
    v_and_b32_e64 v18, 3, v1
    v_lshl_add_u32 v12, v17, 3, v19
    v_lshlrev_b32_e64 v12, 8, v12
    v_add_u32 v12, 32768, v12
    v_and_b32_e64 v13, 1, v17
    v_lshl_add_u32 v13, v13, 2, v19
    v_lshlrev_b32 v13, 5, v13
    v_mul_u32_u24 v14, 40, v18
    v_lshlrev_b32_e64 v15, 3, v18
    v_add_u32 v15, 160, v15
    v_add_u32 v14, v14, v13
    v_add_u32 v15, v15, v13
    v_add_u32_e64 v18, 0, v14
    v_and_b32 v18, 255, v18
    v_add_u32 v212, v18, v12
    v_add_u32 v18, 8, v14
    v_and_b32 v18, 255, v18
    v_add_u32 v213, v18, v12
    v_add_u32 v18, 16, v14
    v_and_b32 v18, 255, v18
    v_add_u32 v214, v18, v12
    v_add_u32 v18, 24, v14
    v_and_b32 v18, 255, v18
    v_add_u32 v215, v18, v12
    v_add_u32 v18, 32, v14
    v_and_b32 v18, 255, v18
    v_add_u32 v216, v18, v12
    v_add_u32 v18, 0, v15
    v_and_b32 v18, 255, v18
    v_add_u32 v217, v18, v12
    v_add_u32 v18, 32, v15
    v_and_b32 v18, 255, v18
    v_add_u32 v218, v18, v12
    v_add_u32 v18, 64, v15
    v_and_b32 v18, 255, v18
    v_add_u32 v219, v18, v12
    s_mov_b32 s64, 0
    s_mul_i32 s31, s67, 5120
    s_add_u32 s31, s31, 32768
    v_lshlrev_b32 v220, 4, v1
    v_add_u32 v220, s31, v220
    v_bfe_u32 v249, v1, 2, 2
    v_and_b32 v250, 3, v1
    v_and_b32 v251, 1, v17
    v_mul_u32_u24_e64 v14, 40, v249
    v_mul_u32_u24 v15, 800, v251
    v_add_u32_e64 v14, v14, v15
    v_add_u32 v14, 147456, v14
    v_cmp_eq_u32 vcc, v250, v17
    v_lshlrev_b32 v15, 3, v1
    v_add_u32 v15, 149120, v15
    v_cndmask_b32 v221, v15, v14, vcc
    v_lshrrev_b32 v252, 1, v17
    v_lshl_add_u32 v14, v252, 4, v16
    s_lshl_b32 s31, s67, 6
    s_lshl_b32 s68, s64, 4
    s_add_u32 s31, s31, s68
    v_add_u32 v14, s31, v14
    v_lshlrev_b32_e64 v14, 8, v14
    v_add_u32 v14, 65536, v14
    v_and_b32 v15, 3, v16
    v_lshrrev_b32 v18, 3, v16
    v_lshl_add_u32 v15, v18, 2, v15
    v_mul_u32_u24 v18, 3, v251
    v_add_u32 v19, 0, v18
    v_xor_b32_e64 v19, v19, v15
    v_lshl_add_u32 v222, v19, 5, v14
    v_add_u32 v19, 1, v18
    v_xor_b32 v19, v19, v15
    v_lshl_add_u32 v223, v19, 5, v14
    v_add_u32 v19, 2, v18
    v_xor_b32 v19, v19, v15
    v_lshl_add_u32 v224, v19, 5, v14
    s_lshr_b32 s31, s3, 2
    s_mul_i32 s69, s31, 3
    s_add_u32 s69, s69, s67
    s_lshl_b32 s68, s31, 3
    v_lshl_add_u32 v14, v17, 3, v249
    v_lshl_add_u32 v15, v251, 2, v249
    v_xor_b32 v15, s69, v15
    v_lshlrev_b32 v15, 5, v15
    v_lshl_add_u32 v15, v14, 8, v15
    v_lshl_add_u32 v229, v250, 3, v15
    v_add_u32 v229, 65536, v229
    v_and_b32 v15, 1, v249
    v_lshrrev_b32 v18, 1, v249
    v_lshl_add_u32 v15, v18, 2, v15
    v_lshl_add_u32 v15, v251, 3, v15
    v_add_u32 v18, s68, v250
    v_xor_b32 v15, v15, v18
    v_lshlrev_b32 v14, 7, v14
    v_add_u32 v14, 0, v14
    v_xor_b32_e64 v18, 0, v15
    v_lshl_add_u32 v230, v18, 3, v14
    v_xor_b32_e64 v18, 2, v15
    v_lshl_add_u32 v231, v18, 3, v14
    v_xor_b32_e64 v18, 4, v15
    v_lshl_add_u32 v232, v18, 3, v14
    v_xor_b32_e64 v18, 6, v15
    v_lshl_add_u32 v233, v18, 3, v14
    s_mul_i32 s31, s31, 210
    s_lshl_b32 s68, s67, 2
    s_add_u32 s31, s31, s68
    v_mul_u32_u24 v14, 10, v16
    v_add_u32 v14, v14, v17
    v_add_u32 v14, s31, v14
    v_lshlrev_b32 v14, 4, v14
    v_add_u32 v15, s68, v17
    v_cmp_lt_u32 vcc, 9, v15
    v_mov_b32 v19, 1073741824
    s_nop 0
    v_cndmask_b32_e64 v234, v14, v19, vcc
    v_add_u32 v14, 2560, v234
    v_cmp_lt_u32 vcc, 4, v16
    s_nop 1
    v_cndmask_b32 v235, v14, v19, vcc
    v_lshrrev_b32 v14, 2, v16
    v_and_b32_e64 v15, 1, v14
    v_cmp_eq_u32 s[74:75], v251, v15
    v_lshrrev_b32 v14, 1, v14
    v_mul_u32_u24 v14, 10, v14
    v_and_b32 v15, 3, v16
    v_add_u32 v14, v14, v15
    v_mul_u32_u24 v18, 2016, v251
    v_mul_u32_u24 v19, 48, v252
    v_add_u32 v18, v18, v19
    v_add_u32 v18, 150400, v18
    v_lshlrev_b32_e64 v19, 4, v1
    v_add_u32 v19, 149120, v19
    v_add_u32_e64 v249, 0, v14
    v_mul_u32_u24 v249, 96, v249
    v_add_u32_e64 v249, v249, v18
    v_cndmask_b32 v240, v19, v249, s[74:75]
    v_add_u32_e64 v249, 4, v14
    v_mul_u32_u24 v249, 96, v249
    v_add_u32_e64 v249, v249, v18
    v_cndmask_b32 v241, v19, v249, s[74:75]
    v_add_u32 v249, 8, v14
    v_cmp_lt_u32 vcc, 1, v15
    v_mov_b32 v250, 20
    s_nop 0
    v_cndmask_b32_e64 v249, v249, v250, vcc
    v_mul_u32_u24 v249, 96, v249
    v_add_u32_e64 v249, v249, v18
    v_cndmask_b32 v242, v19, v249, s[74:75]
    s_mul_i32 s31, s67, 5120
    s_add_u32 s31, s31, 126976
    v_mul_u32_u24 v14, 80, v16
    v_add_u32 v14, s31, v14
    v_mul_u32_u24 v15, 40, v251
    v_mul_u32_u24_e64 v18, 20, v252
    v_add3_u32 v243, v15, v18, v14
    v_add_u32 v244, 1280, v243
    v_lshl_add_u32 v245, v17, 4, v14
    v_mul_u32_u24 v15, 1280, v251
    v_add_u32 v246, v15, v14
    v_lshlrev_b32 v14, 4, v16
    v_lshl_add_u32 v247, v17, 8, v14
    v_mul_u32_u24 v15, 20480, v251
    v_add_u32 v248, v15, v14
    s_lshl_b32 s31, s3, 13
    s_add_u32 s31, s31, 0
    v_lshlrev_b32 v12, 7, v16
    v_add_u32 v12, s31, v12
    v_and_b32 v13, 9, v16
    v_bfe_u32 v14, v16, 2, 1
    v_lshl_add_u32 v13, v14, 1, v13
    v_bfe_u32 v14, v16, 1, 1
    v_lshl_add_u32 v13, v14, 2, v13
    v_add_u32 v14, 0, v17
    v_cmp_lt_u32 vcc, 4, v14
    v_add_u32 v15, 3, v14
    s_nop 0
    v_cndmask_b32 v15, v14, v15, vcc
    v_xor_b32 v15, v15, v13
    v_lshl_add_u32 v225, v15, 3, v12
    v_add_u32 v14, 4, v17
    v_cmp_lt_u32 vcc, 4, v14
    v_add_u32 v15, 3, v14
    s_nop 0
    v_cndmask_b32 v15, v14, v15, vcc
    v_xor_b32 v15, v15, v13
    v_lshl_add_u32 v226, v15, 3, v12
    v_add_u32 v14, 8, v17
    v_cmp_lt_u32 vcc, 4, v14
    v_add_u32 v15, 3, v14
    s_nop 0
    v_cndmask_b32 v15, v14, v15, vcc
    v_lshlrev_b32 v18, 3, v14
    v_subrev_u32 v18, 75, v18
    v_cmp_lt_u32 vcc, 9, v14
    s_nop 1
    v_cndmask_b32_e64 v15, v15, v18, vcc
    v_mov_b32 v228, 0x3f80
    s_mov_b64 s[46:47], vcc
    v_xor_b32 v15, v15, v13
    v_lshl_add_u32 v227, v15, 3, v12
    v_lshlrev_b32_e64 v236, 4, v0
    v_add_u32 v12, 4096, v236
    v_cmp_gt_u32 vcc, 164, v0
    v_mov_b32_e64 v13, 1073741824
    s_mov_b32 s69, 6554
    v_cndmask_b32 v237, v13, v12, vcc
    v_add_u32 v12, 0, v0
    v_mul_u32_u24 v13, s69, v12
    v_lshrrev_b32 v13, 16, v13
    v_mul_u32_u24 v14, 10, v13
    v_sub_u32 v14, v12, v14
    v_mul_u32_u24 v13, 96, v13
    v_lshl_add_u32 v13, v14, 3, v13
    v_cmp_lt_u32 vcc, 4, v14
    v_add_u32 v14, 8, v13
    s_nop 0
    v_cndmask_b32 v13, v13, v14, vcc
    v_add_u32 v238, 150400, v13
    v_add_u32 v12, 256, v0
    v_mul_u32_u24 v13, s69, v12
    v_lshrrev_b32 v13, 16, v13
    v_mul_u32_u24 v14, 10, v13
    v_sub_u32 v14, v12, v14
    v_mul_u32_u24 v13, 96, v13
    v_lshl_add_u32 v13, v14, 3, v13
    v_cmp_lt_u32 vcc, 4, v14
    v_add_u32 v14, 8, v13
    s_nop 0
    v_cndmask_b32 v13, v13, v14, vcc
    v_add_u32 v239, 150400, v13
    v_mul_u32_u24 v12, 43, v1
    v_lshrrev_b32 v12, 8, v12
    v_mul_u32_u24 v13, 6, v12
    v_sub_u32 v13, v1, v13
    v_cmp_lt_u32 vcc, 2, v13
    v_lshlrev_b32 v13, 6, v13
    v_add_u32 v14, 3168, v13
    v_cndmask_b32_e64 v13, v13, v14, vcc
    v_mul_u32_u24 v12, 6912, v12
    v_add3_u32 v12, v12, v13, 64
    v_add_u32 v12, 2496, v12
    v_cmp_lt_u32 vcc, 47, v1
    v_mov_b32 v13, 1073741824
    s_nop 0
    v_cndmask_b32 v254, v12, v13, vcc
    v_mov_b64 v[84:85], 0
    v_mov_b64 v[86:87], 0
    v_mov_b64 v[88:89], 0
    v_mov_b64 v[90:91], 0
    v_mov_b64 v[92:93], 0
    v_mov_b64 v[94:95], 0
    v_mov_b64 v[96:97], 0
    v_mov_b64 v[98:99], 0
    v_mov_b64 v[100:101], 0
    v_mov_b64 v[102:103], 0
    v_mov_b64 v[104:105], 0
    v_mov_b64 v[106:107], 0
    v_mov_b64 v[108:109], 0
    v_mov_b64 v[110:111], 0
    v_mov_b64 v[112:113], 0
    v_mov_b64 v[114:115], 0
    v_mov_b64 v[116:117], 0
    v_mov_b64 v[118:119], 0
    v_mov_b64 v[120:121], 0
    v_mov_b64 v[122:123], 0
    v_mov_b64 v[124:125], 0
    v_mov_b64 v[126:127], 0
    v_mov_b64 v[128:129], 0
    v_mov_b64 v[130:131], 0
    v_mov_b64 v[132:133], 0
    v_mov_b64 v[134:135], 0
    v_mov_b64 v[136:137], 0
    v_mov_b64 v[138:139], 0
    v_mov_b64 v[140:141], 0
    v_mov_b64 v[142:143], 0
    v_mov_b64 v[144:145], 0
    v_mov_b64 v[146:147], 0
    v_mov_b64 v[148:149], 0
    v_mov_b64 v[150:151], 0
    v_mov_b64 v[152:153], 0
    v_mov_b64 v[154:155], 0
    v_mov_b64 v[156:157], 0
    v_mov_b64 v[158:159], 0
    v_mov_b64 v[160:161], 0
    v_mov_b64 v[162:163], 0
    v_mov_b64 v[164:165], 0
    v_mov_b64 v[166:167], 0
    v_mov_b64 v[168:169], 0
    v_mov_b64 v[170:171], 0
    v_mov_b64 v[172:173], 0
    v_mov_b64 v[174:175], 0
    v_mov_b64 v[176:177], 0
    v_mov_b64 v[178:179], 0
    v_mov_b64 v[180:181], 0
    v_mov_b64 v[182:183], 0
    v_mov_b64 v[184:185], 0
    v_mov_b64 v[186:187], 0
    v_mov_b64 v[188:189], 0
    v_mov_b64 v[190:191], 0
    v_mov_b64 v[192:193], 0
    v_mov_b64 v[194:195], 0
    v_mov_b64 v[196:197], 0
    v_mov_b64 v[198:199], 0
    v_mov_b64 v[200:201], 0
    v_mov_b64 v[202:203], 0
    v_mov_b64 v[204:205], 0
    v_mov_b64 v[206:207], 0
    v_mov_b64 v[208:209], 0
    v_mov_b64 v[210:211], 0
    s_cmp_lt_u32 s3, 2
    s_cbranch_scc0 L_wpw_11
    s_waitcnt vmcnt(0)
    v_cmp_gt_u32 vcc, 1600, v2
    s_and_saveexec_b64 s[76:77], vcc
    ds_write_b128 v3, v[4:7]
    s_mov_b64 exec, s[76:77]
    L_wpw_11:
    s_mov_b32 s27, 0
    s_mov_b32 s28, 49152
    s_mov_b32 s66, 49152
    s_mov_b32 s68, 0
    s_mov_b32 s24, 24576
    s_waitcnt lgkmcnt(0)
    s_add_u32 s72, s70, 1
    s_addc_u32 s73, s71, 0
    s_lshl_b32 s31, s3, 2
    v_add_u32 v252, s31, v253
    v_add_u32 v251, 8, v253
    L_f0A:
    ds_read_b64 v[74:75], v253
    s_waitcnt lgkmcnt(0)
    v_min_u32 v74, v74, v75
    s_nop 0
    v_readfirstlane_b32 s31, v74
    s_nop 3
    s_cmp_ge_u32 s31, 1
    s_cbranch_scc1 L_f1A
    s_sleep 1
    s_branch L_f0A
    L_f1A:
    ds_read_b128 v[20:23], v8 offset:0
    ds_read_b128 v[24:27], v8 offset:2048
    ds_read_b128 v[28:31], v8 offset:4096
    ds_read_b128 v[32:35], v8 offset:6144
    ds_read_b64_tr_b16 v[52:53], v212 offset:0
    ds_read_b64_tr_b16 v[54:55], v212 offset:1024
    ds_read_b64_tr_b16 v[56:57], v213 offset:0
    ds_read_b64_tr_b16 v[58:59], v213 offset:1024
    ds_read_b64_tr_b16 v[60:61], v214 offset:0
    ds_read_b64_tr_b16 v[62:63], v214 offset:1024
    ds_read_b64_tr_b16 v[64:65], v215 offset:0
    ds_read_b64_tr_b16 v[66:67], v215 offset:1024
    ds_read_b64_tr_b16 v[68:69], v216 offset:0
    ds_read_b64_tr_b16 v[70:71], v216 offset:1024
    ds_read_b64_tr_b16 v[72:73], v217 offset:0
    ds_read_b64_tr_b16 v[74:75], v217 offset:1024
    ds_read_b64_tr_b16 v[76:77], v218 offset:0
    ds_read_b64_tr_b16 v[78:79], v218 offset:1024
    .p2align 3
L_loopA:
    s_waitcnt lgkmcnt(12)
    s_nop 0
    v_mfma_f32_16x16x32_bf16 v[84:87], v[52:55], v[20:23], v[84:87]
    ds_read_b64_tr_b16 v[80:81], v219 offset:0
    v_mfma_f32_16x16x32_bf16 v[116:119], v[52:55], v[24:27], v[116:119]
    ds_read_b64_tr_b16 v[82:83], v219 offset:1024
    v_mfma_f32_16x16x32_bf16 v[148:151], v[52:55], v[28:31], v[148:151]
    v_mfma_f32_16x16x32_bf16 v[180:183], v[52:55], v[32:35], v[180:183]
    s_waitcnt lgkmcnt(12)
    s_nop 0
    v_mfma_f32_16x16x32_bf16 v[88:91], v[56:59], v[20:23], v[88:91]
    ds_read_b64_tr_b16 v[52:53], v212 offset:8192
    v_mfma_f32_16x16x32_bf16 v[120:123], v[56:59], v[24:27], v[120:123]
    ds_read_b64_tr_b16 v[54:55], v212 offset:9216
    v_mfma_f32_16x16x32_bf16 v[152:155], v[56:59], v[28:31], v[152:155]
    ds_read_b128 v[36:39], v9 offset:0
    v_mfma_f32_16x16x32_bf16 v[184:187], v[56:59], v[32:35], v[184:187]
    ds_read_b128 v[40:43], v9 offset:2048
    s_waitcnt lgkmcnt(14)
    s_nop 0
    v_mfma_f32_16x16x32_bf16 v[92:95], v[60:63], v[20:23], v[92:95]
    ds_read_b64_tr_b16 v[56:57], v213 offset:8192
    v_mfma_f32_16x16x32_bf16 v[124:127], v[60:63], v[24:27], v[124:127]
    ds_read_b64_tr_b16 v[58:59], v213 offset:9216
    v_mfma_f32_16x16x32_bf16 v[156:159], v[60:63], v[28:31], v[156:159]
    ds_read_b128 v[44:47], v9 offset:4096
    v_mfma_f32_16x16x32_bf16 v[188:191], v[60:63], v[32:35], v[188:191]
    ds_read_b128 v[48:51], v9 offset:6144
    v_add_u32_e64 v212, s28, v212
    s_add_u32 s27, s27, 1
    s_waitcnt lgkmcnt(15)
    v_mfma_f32_16x16x32_bf16 v[96:99], v[64:67], v[20:23], v[96:99]
    ds_read_b64_tr_b16 v[60:61], v214 offset:8192
    v_mfma_f32_16x16x32_bf16 v[128:131], v[64:67], v[24:27], v[128:131]
    ds_read_b64_tr_b16 v[62:63], v214 offset:9216
    v_mfma_f32_16x16x32_bf16 v[160:163], v[64:67], v[28:31], v[160:163]
    v_add_u32_e64 v213, s28, v213
    v_mfma_f32_16x16x32_bf16 v[192:195], v[64:67], v[32:35], v[192:195]
    v_add_u32 v8, s28, v8
    v_add_u32 v9, s28, v9
    s_add_u32 s68, s68, 1
    s_cmp_eq_u32 s68, 3
    s_cselect_b32 s68, 0, s68
    s_waitcnt lgkmcnt(15)
    v_mfma_f32_16x16x32_bf16 v[100:103], v[68:71], v[20:23], v[100:103]
    ds_read_b64_tr_b16 v[64:65], v215 offset:8192
    v_mfma_f32_16x16x32_bf16 v[132:135], v[68:71], v[24:27], v[132:135]
    ds_read_b64_tr_b16 v[66:67], v215 offset:9216
    v_mfma_f32_16x16x32_bf16 v[164:167], v[68:71], v[28:31], v[164:167]
    v_add_u32_e64 v214, s28, v214
    v_mfma_f32_16x16x32_bf16 v[196:199], v[68:71], v[32:35], v[196:199]
    s_cmp_eq_u32 s68, 2
    s_nop 0
    s_cselect_b32 s69, 4294868992, s66
    s_waitcnt lgkmcnt(15)
    s_nop 0
    v_mfma_f32_16x16x32_bf16 v[104:107], v[72:75], v[20:23], v[104:107]
    ds_read_b64_tr_b16 v[68:69], v216 offset:8192
    v_mfma_f32_16x16x32_bf16 v[136:139], v[72:75], v[24:27], v[136:139]
    ds_read_b64_tr_b16 v[70:71], v216 offset:9216
    v_mfma_f32_16x16x32_bf16 v[168:171], v[72:75], v[28:31], v[168:171]
    v_add_u32_e64 v215, s28, v215
    v_mfma_f32_16x16x32_bf16 v[200:203], v[72:75], v[32:35], v[200:203]
    s_waitcnt lgkmcnt(15)
    s_nop 0
    v_mfma_f32_16x16x32_bf16 v[108:111], v[76:79], v[20:23], v[108:111]
    ds_read_b64_tr_b16 v[72:73], v217 offset:8192
    v_mfma_f32_16x16x32_bf16 v[140:143], v[76:79], v[24:27], v[140:143]
    ds_read_b64_tr_b16 v[74:75], v217 offset:9216
    v_mfma_f32_16x16x32_bf16 v[172:175], v[76:79], v[28:31], v[172:175]
    v_add_u32_e64 v216, s28, v216
    v_mfma_f32_16x16x32_bf16 v[204:207], v[76:79], v[32:35], v[204:207]
    s_waitcnt lgkmcnt(15)
    s_nop 0
    v_mfma_f32_16x16x32_bf16 v[112:115], v[80:83], v[20:23], v[112:115]
    ds_read_b64_tr_b16 v[76:77], v218 offset:8192
    v_mfma_f32_16x16x32_bf16 v[144:147], v[80:83], v[24:27], v[144:147]
    ds_read_b64_tr_b16 v[78:79], v218 offset:9216
    v_mfma_f32_16x16x32_bf16 v[176:179], v[80:83], v[28:31], v[176:179]
    v_add_u32_e64 v217, s28, v217
    v_mfma_f32_16x16x32_bf16 v[208:211], v[80:83], v[32:35], v[208:211]
    s_waitcnt lgkmcnt(10)
    s_nop 0
    v_mfma_f32_16x16x32_bf16 v[84:87], v[52:55], v[36:39], v[84:87]
    ds_read_b64_tr_b16 v[80:81], v219 offset:8192
    v_mfma_f32_16x16x32_bf16 v[116:119], v[52:55], v[40:43], v[116:119]
    ds_read_b64_tr_b16 v[82:83], v219 offset:9216
    v_mfma_f32_16x16x32_bf16 v[148:151], v[52:55], v[44:47], v[148:151]
    v_add_u32_e64 v218, s28, v218
    v_mfma_f32_16x16x32_bf16 v[180:183], v[52:55], v[48:51], v[180:183]
    v_mfma_f32_16x16x32_bf16 v[88:91], v[56:59], v[36:39], v[88:91]
    v_add_u32_e64 v219, s28, v219
    v_mfma_f32_16x16x32_bf16 v[120:123], v[56:59], v[40:43], v[120:123]
    v_mfma_f32_16x16x32_bf16 v[152:155], v[56:59], v[44:47], v[152:155]
    v_mfma_f32_16x16x32_bf16 v[184:187], v[56:59], v[48:51], v[184:187]
    ds_read_b64 v[20:21], v251
    v_mov_b32 v249, s27
    s_cmp_lt_u32 s27, 10
    s_cselect_b32 s23, s27, 0
    s_waitcnt lgkmcnt(11)
    v_mfma_f32_16x16x32_bf16 v[92:95], v[60:63], v[36:39], v[92:95]
    v_mfma_f32_16x16x32_bf16 v[124:127], v[60:63], v[40:43], v[124:127]
    v_mfma_f32_16x16x32_bf16 v[156:159], v[60:63], v[44:47], v[156:159]
    v_mfma_f32_16x16x32_bf16 v[188:191], v[60:63], v[48:51], v[188:191]
    s_waitcnt lgkmcnt(0)
    v_min_u32 v20, v20, v21
    ds_write_b32 v252, v249 offset:16
    v_readfirstlane_b32 s31, v20
    s_nop 1
    s_cmp_gt_u32 s31, s23
    s_cbranch_scc1 L_fkA
    L_fwA:
    ds_read_b64 v[20:21], v251
    s_waitcnt lgkmcnt(0)
    v_min_u32 v20, v20, v21
    ds_write_b32 v252, v249 offset:16
    v_readfirstlane_b32 s31, v20
    s_nop 1
    s_cmp_gt_u32 s31, s23
    s_cbranch_scc0 L_fwA
    L_fkA:
    v_xor_b32_e64 v251, 8, v251
    v_mfma_f32_16x16x32_bf16 v[96:99], v[64:67], v[36:39], v[96:99]
    ds_read_b128 v[20:23], v8 offset:0
    v_mfma_f32_16x16x32_bf16 v[128:131], v[64:67], v[40:43], v[128:131]
    ds_read_b128 v[24:27], v8 offset:2048
    v_mfma_f32_16x16x32_bf16 v[160:163], v[64:67], v[44:47], v[160:163]
    ds_read_b128 v[28:31], v8 offset:4096
    v_mfma_f32_16x16x32_bf16 v[192:195], v[64:67], v[48:51], v[192:195]
    ds_read_b128 v[32:35], v8 offset:6144
    v_mfma_f32_16x16x32_bf16 v[100:103], v[68:71], v[36:39], v[100:103]
    ds_read_b64_tr_b16 v[52:53], v212 offset:0
    v_mfma_f32_16x16x32_bf16 v[132:135], v[68:71], v[40:43], v[132:135]
    ds_read_b64_tr_b16 v[54:55], v212 offset:1024
    v_mfma_f32_16x16x32_bf16 v[164:167], v[68:71], v[44:47], v[164:167]
    ds_read_b64_tr_b16 v[56:57], v213 offset:0
    v_mfma_f32_16x16x32_bf16 v[196:199], v[68:71], v[48:51], v[196:199]
    ds_read_b64_tr_b16 v[58:59], v213 offset:1024
    v_mfma_f32_16x16x32_bf16 v[104:107], v[72:75], v[36:39], v[104:107]
    ds_read_b64_tr_b16 v[60:61], v214 offset:0
    v_mfma_f32_16x16x32_bf16 v[136:139], v[72:75], v[40:43], v[136:139]
    ds_read_b64_tr_b16 v[62:63], v214 offset:1024
    v_mfma_f32_16x16x32_bf16 v[168:171], v[72:75], v[44:47], v[168:171]
    ds_read_b64_tr_b16 v[64:65], v215 offset:0
    v_mfma_f32_16x16x32_bf16 v[200:203], v[72:75], v[48:51], v[200:203]
    ds_read_b64_tr_b16 v[66:67], v215 offset:1024
    v_mfma_f32_16x16x32_bf16 v[108:111], v[76:79], v[36:39], v[108:111]
    ds_read_b64_tr_b16 v[68:69], v216 offset:0
    v_mfma_f32_16x16x32_bf16 v[140:143], v[76:79], v[40:43], v[140:143]
    ds_read_b64_tr_b16 v[70:71], v216 offset:1024
    v_mfma_f32_16x16x32_bf16 v[172:175], v[76:79], v[44:47], v[172:175]
    ds_read_b64_tr_b16 v[72:73], v217 offset:0
    v_mfma_f32_16x16x32_bf16 v[204:207], v[76:79], v[48:51], v[204:207]
    ds_read_b64_tr_b16 v[74:75], v217 offset:1024
    v_mfma_f32_16x16x32_bf16 v[112:115], v[80:83], v[36:39], v[112:115]
    ds_read_b64_tr_b16 v[76:77], v218 offset:0
    v_mfma_f32_16x16x32_bf16 v[144:147], v[80:83], v[40:43], v[144:147]
    ds_read_b64_tr_b16 v[78:79], v218 offset:1024
    v_mfma_f32_16x16x32_bf16 v[176:179], v[80:83], v[44:47], v[176:179]
    v_mfma_f32_16x16x32_bf16 v[208:211], v[80:83], v[48:51], v[208:211]
    s_mov_b32 s28, s69
    s_sub_u32 s24, 0, s24
    s_cmp_lt_u32 s27, 10
    s_cbranch_scc1 L_loopA
    s_waitcnt lgkmcnt(0)
    ds_read_b64_tr_b16 v[30:31], v221 offset:0
    ds_read_b64_tr_b16 v[32:33], v221 offset:160
    ds_read_b64_tr_b16 v[34:35], v221 offset:320
    ds_read_b64_tr_b16 v[36:37], v221 offset:480
    ds_read_b64_tr_b16 v[38:39], v221 offset:640
    ds_read_b64_tr_b16 v[40:41], v221 offset:8
    ds_read_b64_tr_b16 v[42:43], v221 offset:168
    ds_read_b64_tr_b16 v[44:45], v221 offset:328
    ds_read_b64_tr_b16 v[46:47], v221 offset:488
    ds_read_b64_tr_b16 v[48:49], v221 offset:648
    ds_read_b64_tr_b16 v[50:51], v221 offset:16
    ds_read_b64_tr_b16 v[52:53], v221 offset:176
    ds_read_b64_tr_b16 v[54:55], v221 offset:336
    ds_read_b64_tr_b16 v[56:57], v221 offset:496
    ds_read_b64_tr_b16 v[58:59], v221 offset:656
    ds_read_b64_tr_b16 v[60:61], v221 offset:24
    ds_read_b64_tr_b16 v[62:63], v221 offset:184
    ds_read_b64_tr_b16 v[64:65], v221 offset:344
    ds_read_b64_tr_b16 v[66:67], v221 offset:504
    ds_read_b64_tr_b16 v[68:69], v221 offset:664
    ds_read_b64_tr_b16 v[70:71], v221 offset:32
    ds_read_b64_tr_b16 v[72:73], v221 offset:192
    ds_read_b64_tr_b16 v[74:75], v221 offset:352
    ds_read_b64_tr_b16 v[76:77], v221 offset:512
    ds_read_b64_tr_b16 v[78:79], v221 offset:672
    s_barrier
    v_cvt_pk_bf16_f32 v148, v148, v149
    v_cvt_pk_bf16_f32 v149, v150, v151
    v_cvt_pk_bf16_f32 v150, v152, v153
    v_cvt_pk_bf16_f32 v151, v154, v155
    v_cvt_pk_bf16_f32 v152, v156, v157
    v_cvt_pk_bf16_f32 v153, v158, v159
    v_cvt_pk_bf16_f32 v154, v160, v161
    v_cvt_pk_bf16_f32 v155, v162, v163
    v_cvt_pk_bf16_f32 v156, v164, v165
    v_cvt_pk_bf16_f32 v157, v166, v167
    v_cvt_pk_bf16_f32 v158, v180, v181
    v_cvt_pk_bf16_f32 v159, v182, v183
    v_cvt_pk_bf16_f32 v160, v184, v185
    v_cvt_pk_bf16_f32 v161, v186, v187
    v_cvt_pk_bf16_f32 v162, v188, v189
    v_cvt_pk_bf16_f32 v163, v190, v191
    v_cvt_pk_bf16_f32 v164, v192, v193
    v_cvt_pk_bf16_f32 v165, v194, v195
    v_cvt_pk_bf16_f32 v166, v196, v197
    v_cvt_pk_bf16_f32 v167, v198, v199
    ds_write_b128 v220, v[148:151] offset:0
    ds_write_b128 v220, v[152:155] offset:1024
    ds_write_b128 v220, v[156:159] offset:2048
    ds_write_b128 v220, v[160:163] offset:3072
    ds_write_b128 v220, v[164:167] offset:4096
    v_cvt_pk_bf16_f32 v80, v84, v85
    v_cvt_pk_bf16_f32 v81, v86, v87
    v_cvt_pk_bf16_f32 v82, v88, v89
    v_cvt_pk_bf16_f32 v83, v90, v91
    v_cvt_pk_bf16_f32 v84, v92, v93
    v_cvt_pk_bf16_f32 v85, v94, v95
    v_cvt_pk_bf16_f32 v86, v96, v97
    v_cvt_pk_bf16_f32 v87, v98, v99
    v_cvt_pk_bf16_f32 v88, v100, v101
    v_cvt_pk_bf16_f32 v89, v102, v103
    s_waitcnt lgkmcnt(0)
    s_barrier
    v_cvt_pk_bf16_f32 v90, v116, v117
    v_cvt_pk_bf16_f32 v91, v118, v119
    v_cvt_pk_bf16_f32 v92, v120, v121
    v_cvt_pk_bf16_f32 v93, v122, v123
    v_cvt_pk_bf16_f32 v94, v124, v125
    v_cvt_pk_bf16_f32 v95, v126, v127
    v_cvt_pk_bf16_f32 v96, v128, v129
    v_cvt_pk_bf16_f32 v97, v130, v131
    v_cvt_pk_bf16_f32 v98, v132, v133
    v_cvt_pk_bf16_f32 v99, v134, v135
    s_mov_b32 s78, 1069066811
    s_nop 0
    v_permlane32_swap_b32 v80, v90
    v_permlane32_swap_b32 v81, v91
    v_permlane32_swap_b32 v82, v92
    v_permlane32_swap_b32 v83, v93
    v_permlane32_swap_b32 v84, v94
    v_permlane32_swap_b32 v85, v95
    v_permlane32_swap_b32 v86, v96
    v_permlane32_swap_b32 v87, v97
    v_permlane32_swap_b32 v88, v98
    v_permlane32_swap_b32 v89, v99
    s_nop 0
    v_mfma_f32_16x16x32_bf16 v[116:119], v[30:33], v[90:93], 0
    v_cvt_pk_bf16_f32 v104, v104, v105
    v_cvt_pk_bf16_f32 v105, v106, v107
    ds_write_b64 v225, v[104:105] offset:0
    v_mfma_f32_16x16x32_bf16 v[120:123], v[40:43], v[90:93], 0
    v_cvt_pk_bf16_f32 v108, v108, v109
    v_cvt_pk_bf16_f32 v109, v110, v111
    ds_write_b64 v226, v[108:109] offset:0
    v_mfma_f32_16x16x32_bf16 v[124:127], v[50:53], v[90:93], 0
    v_cvt_pk_bf16_f32 v112, v112, v113
    v_cvt_pk_bf16_f32 v113, v114, v115
    v_cndmask_b32 v112, v112, v228, s[46:47]
    v_mfma_f32_16x16x32_bf16 v[128:131], v[60:63], v[90:93], 0
    ds_write_b64 v227, v[112:113] offset:0
    v_cvt_pk_bf16_f32 v136, v136, v137
    v_cvt_pk_bf16_f32 v137, v138, v139
    v_mfma_f32_16x16x32_bf16 v[132:135], v[70:73], v[90:93], 0
    ds_write_b64 v225, v[136:137] offset:2048
    v_cvt_pk_bf16_f32 v140, v140, v141
    v_cvt_pk_bf16_f32 v141, v142, v143
    v_mfma_f32_16x16x32_bf16 v[116:119], v[34:37], v[94:97], v[116:119]
    ds_write_b64 v226, v[140:141] offset:2048
    v_cvt_pk_bf16_f32 v144, v144, v145
    v_cvt_pk_bf16_f32 v145, v146, v147
    v_mfma_f32_16x16x32_bf16 v[120:123], v[44:47], v[94:97], v[120:123]
    v_cndmask_b32 v144, v144, v228, s[46:47]
    ds_write_b64 v227, v[144:145] offset:2048
    v_cvt_pk_bf16_f32 v168, v168, v169
    v_mfma_f32_16x16x32_bf16 v[124:127], v[54:57], v[94:97], v[124:127]
    v_cvt_pk_bf16_f32 v169, v170, v171
    ds_write_b64 v225, v[168:169] offset:4096
    v_cvt_pk_bf16_f32 v172, v172, v173
    v_mfma_f32_16x16x32_bf16 v[128:131], v[64:67], v[94:97], v[128:131]
    v_cvt_pk_bf16_f32 v173, v174, v175
    ds_write_b64 v226, v[172:173] offset:4096
    v_cvt_pk_bf16_f32 v176, v176, v177
    v_mfma_f32_16x16x32_bf16 v[132:135], v[74:77], v[94:97], v[132:135]
    v_cvt_pk_bf16_f32 v177, v178, v179
    v_cndmask_b32 v176, v176, v228, s[46:47]
    ds_write_b64 v227, v[176:177] offset:4096
    v_mfma_f32_16x16x16_bf16 v[116:119], v[38:39], v[98:99], v[116:119]
    v_cvt_pk_bf16_f32 v200, v200, v201
    v_cvt_pk_bf16_f32 v201, v202, v203
    ds_write_b64 v225, v[200:201] offset:6144
    v_mfma_f32_16x16x16_bf16 v[120:123], v[48:49], v[98:99], v[120:123]
    v_cvt_pk_bf16_f32 v204, v204, v205
    v_cvt_pk_bf16_f32 v205, v206, v207
    ds_write_b64 v226, v[204:205] offset:6144
    v_mfma_f32_16x16x16_bf16 v[124:127], v[58:59], v[98:99], v[124:127]
    v_cvt_pk_bf16_f32 v208, v208, v209
    v_cvt_pk_bf16_f32 v209, v210, v211
    v_cndmask_b32 v208, v208, v228, s[46:47]
    v_mfma_f32_16x16x16_bf16 v[128:131], v[68:69], v[98:99], v[128:131]
    ds_write_b64 v227, v[208:209] offset:6144
    v_mfma_f32_16x16x16_bf16 v[132:135], v[78:79], v[98:99], v[132:135]
    s_branch L_A_common
L_A_helper:
    s_mov_b32 s78, 1069066811
    s_barrier
    s_barrier
    ds_read_b128 v[80:83], v220 offset:0
    ds_read_b128 v[84:87], v220 offset:1024
    ds_read_b128 v[88:91], v220 offset:2048
    ds_read_b128 v[92:95], v220 offset:3072
    ds_read_b128 v[96:99], v220 offset:4096
    s_waitcnt lgkmcnt(0)
    v_permlane32_swap_b32 v80, v90
    v_permlane32_swap_b32 v81, v91
    v_permlane32_swap_b32 v82, v92
    v_permlane32_swap_b32 v83, v93
    v_permlane32_swap_b32 v84, v94
    v_permlane32_swap_b32 v85, v95
    v_permlane32_swap_b32 v86, v96
    v_permlane32_swap_b32 v87, v97
    v_permlane32_swap_b32 v88, v98
    v_permlane32_swap_b32 v89, v99
    s_nop 0
    v_mfma_f32_16x16x32_bf16 v[116:119], v[30:33], v[90:93], 0
    v_mfma_f32_16x16x32_bf16 v[120:123], v[40:43], v[90:93], 0
    v_mfma_f32_16x16x32_bf16 v[124:127], v[50:53], v[90:93], 0
    v_mfma_f32_16x16x32_bf16 v[128:131], v[60:63], v[90:93], 0
    v_mfma_f32_16x16x32_bf16 v[132:135], v[70:73], v[90:93], 0
    v_mfma_f32_16x16x32_bf16 v[116:119], v[34:37], v[94:97], v[116:119]
    v_mfma_f32_16x16x32_bf16 v[120:123], v[44:47], v[94:97], v[120:123]
    v_mfma_f32_16x16x32_bf16 v[124:127], v[54:57], v[94:97], v[124:127]
    v_mfma_f32_16x16x32_bf16 v[128:131], v[64:67], v[94:97], v[128:131]
    v_mfma_f32_16x16x32_bf16 v[132:135], v[74:77], v[94:97], v[132:135]
    v_mfma_f32_16x16x16_bf16 v[116:119], v[38:39], v[98:99], v[116:119]
    v_mfma_f32_16x16x16_bf16 v[120:123], v[48:49], v[98:99], v[120:123]
    v_mfma_f32_16x16x16_bf16 v[124:127], v[58:59], v[98:99], v[124:127]
    v_mfma_f32_16x16x16_bf16 v[128:131], v[68:69], v[98:99], v[128:131]
    v_mfma_f32_16x16x16_bf16 v[132:135], v[78:79], v[98:99], v[132:135]
    s_nop 4
L_A_common:
    v_max3_f32 v2, v116, v117, v118
    v_min3_f32 v3, v116, v117, v118
    v_max3_f32 v2, v2, v119, v120
    v_min3_f32 v3, v3, v119, v120
    v_max3_f32 v2, v2, v121, v122
    v_min3_f32 v3, v3, v121, v122
    v_max3_f32 v2, v2, v123, v124
    v_min3_f32 v3, v3, v123, v124
    v_max3_f32 v2, v2, v125, v126
    v_min3_f32 v3, v3, v125, v126
    v_max3_f32 v2, v2, v127, v128
    v_min3_f32 v3, v3, v127, v128
    v_max3_f32 v2, v2, v129, v130
    v_min3_f32 v3, v3, v129, v130
    v_max3_f32 v2, v2, v131, v132
    v_min3_f32 v3, v3, v131, v132
    v_max3_f32 v2, v2, v133, v134
    v_min3_f32 v3, v3, v133, v134
    v_max_f32 v2, v2, v135
    v_min_f32 v3, v3, v135
    v_mul_f32 v2, s78, v2
    v_mul_f32 v3, s78, v3
    v_fma_f32 v148, v116, s78, -v2
    v_fma_f32 v180, -v116, s78, v3
    v_fma_f32 v149, v117, s78, -v2
    v_fma_f32 v181, -v117, s78, v3
    v_fma_f32 v150, v118, s78, -v2
    v_fma_f32 v182, -v118, s78, v3
    v_fma_f32 v151, v119, s78, -v2
    v_fma_f32 v183, -v119, s78, v3
    v_fma_f32 v152, v120, s78, -v2
    v_fma_f32 v184, -v120, s78, v3
    v_fma_f32 v153, v121, s78, -v2
    v_fma_f32 v185, -v121, s78, v3
    v_fma_f32 v154, v122, s78, -v2
    v_fma_f32 v186, -v122, s78, v3
    v_fma_f32 v155, v123, s78, -v2
    v_fma_f32 v187, -v123, s78, v3
    v_fma_f32 v156, v124, s78, -v2
    v_fma_f32 v188, -v124, s78, v3
    v_fma_f32 v157, v125, s78, -v2
    v_fma_f32 v189, -v125, s78, v3
    v_fma_f32 v158, v126, s78, -v2
    v_fma_f32 v190, -v126, s78, v3
    v_fma_f32 v159, v127, s78, -v2
    v_fma_f32 v191, -v127, s78, v3
    v_fma_f32 v160, v128, s78, -v2
    v_fma_f32 v192, -v128, s78, v3
    v_fma_f32 v161, v129, s78, -v2
    v_fma_f32 v193, -v129, s78, v3
    v_fma_f32 v162, v130, s78, -v2
    v_fma_f32 v194, -v130, s78, v3
    v_fma_f32 v163, v131, s78, -v2
    v_fma_f32 v195, -v131, s78, v3
    v_fma_f32 v164, v132, s78, -v2
    v_fma_f32 v196, -v132, s78, v3
    v_fma_f32 v165, v133, s78, -v2
    v_fma_f32 v197, -v133, s78, v3
    v_fma_f32 v166, v134, s78, -v2
    v_fma_f32 v198, -v134, s78, v3
    v_fma_f32 v167, v135, s78, -v2
    v_fma_f32 v199, -v135, s78, v3
    v_exp_f32 v148, v148
    v_exp_f32 v149, v149
    v_exp_f32 v150, v150
    v_exp_f32 v151, v151
    v_exp_f32 v152, v152
    v_exp_f32 v153, v153
    v_exp_f32 v154, v154
    v_exp_f32 v155, v155
    v_exp_f32 v156, v156
    v_exp_f32 v157, v157
    v_exp_f32 v158, v158
    v_exp_f32 v159, v159
    v_exp_f32 v160, v160
    v_exp_f32 v161, v161
    v_exp_f32 v162, v162
    v_exp_f32 v163, v163
    v_exp_f32 v164, v164
    v_exp_f32 v165, v165
    v_exp_f32 v166, v166
    v_exp_f32 v167, v167
    v_exp_f32 v180, v180
    v_exp_f32 v181, v181
    v_exp_f32 v182, v182
    v_exp_f32 v183, v183
    v_exp_f32 v184, v184
    v_exp_f32 v185, v185
    v_exp_f32 v186, v186
    v_exp_f32 v187, v187
    v_exp_f32 v188, v188
    v_exp_f32 v189, v189
    v_exp_f32 v190, v190
    v_exp_f32 v191, v191
    v_exp_f32 v192, v192
    v_exp_f32 v193, v193
    v_exp_f32 v194, v194
    v_exp_f32 v195, v195
    v_exp_f32 v196, v196
    v_exp_f32 v197, v197
    v_exp_f32 v198, v198
    v_exp_f32 v199, v199
    v_add_f32 v4, v148, v149
    v_add_f32 v5, v150, v151
    v_add_f32 v6, v180, v181
    v_add_f32 v7, v182, v183
    v_add_f32 v4, v4, v152
    v_add_f32 v5, v5, v153
    v_add_f32 v6, v6, v184
    v_add_f32 v7, v7, v185
    v_add_f32 v4, v4, v154
    v_add_f32 v5, v5, v155
    v_add_f32 v6, v6, v186
    v_add_f32 v7, v7, v187
    v_add_f32 v4, v4, v156
    v_add_f32 v5, v5, v157
    v_add_f32 v6, v6, v188
    v_add_f32 v7, v7, v189
    v_add_f32 v4, v4, v158
    v_add_f32 v5, v5, v159
    v_add_f32 v6, v6, v190
    v_add_f32 v7, v7, v191
    v_add_f32 v4, v4, v160
    v_add_f32 v5, v5, v161
    v_add_f32 v6, v6, v192
    v_add_f32 v7, v7, v193
    v_add_f32 v4, v4, v162
    v_add_f32 v5, v5, v163
    v_add_f32 v6, v6, v194
    v_add_f32 v7, v7, v195
    v_add_f32 v4, v4, v164
    v_add_f32 v5, v5, v165
    v_add_f32 v6, v6, v196
    v_add_f32 v7, v7, v197
    v_add_f32 v4, v4, v166
    v_add_f32 v5, v5, v167
    v_add_f32 v6, v6, v198
    v_add_f32 v7, v7, v199
    v_add_f32 v4, v4, v5
    v_add_f32 v6, v6, v7
    v_rcp_f32 v4, v4
    v_rcp_f32 v6, v6
    s_nop 0
    v_mul_f32 v148, v148, v4
    v_mul_f32 v149, v149, v4
    v_mul_f32 v150, v150, v4
    v_mul_f32 v151, v151, v4
    v_mul_f32 v152, v152, v4
    v_mul_f32 v153, v153, v4
    v_mul_f32 v154, v154, v4
    v_mul_f32 v155, v155, v4
    v_mul_f32 v156, v156, v4
    v_mul_f32 v157, v157, v4
    v_mul_f32 v158, v158, v4
    v_mul_f32 v159, v159, v4
    v_mul_f32 v160, v160, v4
    v_mul_f32 v161, v161, v4
    v_mul_f32 v162, v162, v4
    v_mul_f32 v163, v163, v4
    v_mul_f32 v164, v164, v4
    v_mul_f32 v165, v165, v4
    v_mul_f32 v166, v166, v4
    v_mul_f32 v167, v167, v4
    v_mul_f32 v180, v180, v6
    v_mul_f32 v181, v181, v6
    v_mul_f32 v182, v182, v6
    v_mul_f32 v183, v183, v6
    v_mul_f32 v184, v184, v6
    v_mul_f32 v185, v185, v6
    v_mul_f32 v186, v186, v6
    v_mul_f32 v187, v187, v6
    v_mul_f32 v188, v188, v6
    v_mul_f32 v189, v189, v6
    v_mul_f32 v190, v190, v6
    v_mul_f32 v191, v191, v6
    v_mul_f32 v192, v192, v6
    v_mul_f32 v193, v193, v6
    v_mul_f32 v194, v194, v6
    v_mul_f32 v195, v195, v6
    v_mul_f32 v196, v196, v6
    v_mul_f32 v197, v197, v6
    v_mul_f32 v198, v198, v6
    v_mul_f32_e64 v199, v199, v6
    v_cvt_pk_bf16_f32 v116, v148, v149
    v_cvt_pk_bf16_f32 v117, v150, v151
    v_cvt_pk_bf16_f32 v118, v152, v153
    v_cvt_pk_bf16_f32 v119, v154, v155
    v_cvt_pk_bf16_f32 v120, v156, v157
    v_cvt_pk_bf16_f32 v121, v158, v159
    v_cvt_pk_bf16_f32 v122, v160, v161
    v_cvt_pk_bf16_f32 v123, v162, v163
    v_cvt_pk_bf16_f32 v124, v164, v165
    v_cvt_pk_bf16_f32 v125, v166, v167
    v_cvt_pk_bf16_f32 v126, v180, v181
    v_cvt_pk_bf16_f32 v127, v182, v183
    v_cvt_pk_bf16_f32 v128, v184, v185
    v_cvt_pk_bf16_f32 v129, v186, v187
    v_cvt_pk_bf16_f32 v130, v188, v189
    v_cvt_pk_bf16_f32 v131, v190, v191
    v_cvt_pk_bf16_f32 v132, v192, v193
    v_cvt_pk_bf16_f32 v133, v194, v195
    v_cvt_pk_bf16_f32 v134, v196, v197
    v_cvt_pk_bf16_f32 v135, v198, v199
    ds_write_b128 v222, v[116:119] offset:0
    ds_write_b128 v222, v[120:123] offset:16
    ds_write_b128 v223, v[124:127] offset:0
    ds_write_b128 v223, v[128:131] offset:16
    ds_write_b128 v224, v[132:135] offset:0
    s_waitcnt lgkmcnt(0)
    s_barrier
    s_cmp_eq_u32 s67, 3
    s_cbranch_scc1 L_A_nokv
    ds_read_b64_tr_b16 v[136:137], v229 offset:0
    ds_read_b64_tr_b16 v[138:139], v229 offset:1024
    ds_read_b64_tr_b16 v[140:141], v230 offset:0
    ds_read_b64_tr_b16 v[142:143], v231 offset:512
    ds_read_b64_tr_b16 v[144:145], v232 offset:0
    ds_read_b64_tr_b16 v[146:147], v233 offset:512
    ds_read_b64_tr_b16 v[148:149], v229 offset:8192
    ds_read_b64_tr_b16 v[150:151], v229 offset:9216
    ds_read_b64_tr_b16 v[152:153], v230 offset:4096
    ds_read_b64_tr_b16 v[154:155], v231 offset:4608
    ds_read_b64_tr_b16 v[156:157], v232 offset:4096
    ds_read_b64_tr_b16 v[158:159], v233 offset:4608
    s_lshl_b32 s31, s21, 3
    s_add_u32 s31, s31, s20
    s_mul_i32 s31, s31, 6912
    s_add_u32 s31, s31, 131072
    ds_read_b64_tr_b16 v[160:161], v229 offset:16384
    ds_read_b64_tr_b16 v[162:163], v229 offset:17408
    ds_read_b64_tr_b16 v[164:165], v230 offset:8192
    ds_read_b64_tr_b16 v[166:167], v231 offset:8704
    ds_read_b64_tr_b16 v[168:169], v232 offset:8192
    ds_read_b64_tr_b16 v[170:171], v233 offset:8704
    s_waitcnt lgkmcnt(12)
    v_mfma_f32_16x16x32_bf16 v[184:187], v[136:139], v[140:143], 0
    v_mfma_f32_16x16x32_bf16 v[188:191], v[136:139], v[144:147], 0
    ds_read_b64_tr_b16 v[172:173], v229 offset:24576
    ds_read_b64_tr_b16 v[174:175], v229 offset:25600
    ds_read_b64_tr_b16 v[176:177], v230 offset:12288
    ds_read_b64_tr_b16 v[178:179], v231 offset:12800
    ds_read_b64_tr_b16 v[180:181], v232 offset:12288
    ds_read_b64_tr_b16 v[182:183], v233 offset:12800
    s_waitcnt lgkmcnt(12)
    v_mfma_f32_16x16x32_bf16 v[184:187], v[148:151], v[152:155], v[184:187]
    v_mfma_f32_16x16x32_bf16 v[188:191], v[148:151], v[156:159], v[188:191]
    ds_read_b64_tr_b16 v[136:137], v229 offset:32768
    ds_read_b64_tr_b16 v[138:139], v229 offset:33792
    ds_read_b64_tr_b16 v[140:141], v230 offset:16384
    ds_read_b64_tr_b16 v[142:143], v231 offset:16896
    ds_read_b64_tr_b16 v[144:145], v232 offset:16384
    ds_read_b64_tr_b16 v[146:147], v233 offset:16896
    s_waitcnt lgkmcnt(12)
    v_mfma_f32_16x16x32_bf16 v[184:187], v[160:163], v[164:167], v[184:187]
    v_mfma_f32_16x16x32_bf16 v[188:191], v[160:163], v[168:171], v[188:191]
    ds_read_b64_tr_b16 v[148:149], v229 offset:40960
    ds_read_b64_tr_b16 v[150:151], v229 offset:41984
    ds_read_b64_tr_b16 v[152:153], v230 offset:20480
    ds_read_b64_tr_b16 v[154:155], v231 offset:20992
    ds_read_b64_tr_b16 v[156:157], v232 offset:20480
    ds_read_b64_tr_b16 v[158:159], v233 offset:20992
    s_waitcnt lgkmcnt(12)
    v_mfma_f32_16x16x32_bf16 v[184:187], v[172:175], v[176:179], v[184:187]
    v_mfma_f32_16x16x32_bf16 v[188:191], v[172:175], v[180:183], v[188:191]
    ds_read_b64_tr_b16 v[160:161], v229 offset:49152
    ds_read_b64_tr_b16 v[162:163], v229 offset:50176
    ds_read_b64_tr_b16 v[164:165], v230 offset:24576
    ds_read_b64_tr_b16 v[166:167], v231 offset:25088
    ds_read_b64_tr_b16 v[168:169], v232 offset:24576
    ds_read_b64_tr_b16 v[170:171], v233 offset:25088
    s_waitcnt lgkmcnt(12)
    v_mfma_f32_16x16x32_bf16 v[184:187], v[136:139], v[140:143], v[184:187]
    v_mfma_f32_16x16x32_bf16 v[188:191], v[136:139], v[144:147], v[188:191]
    ds_read_b64_tr_b16 v[172:173], v229 offset:57344
    ds_read_b64_tr_b16 v[174:175], v229 offset:58368
    ds_read_b64_tr_b16 v[176:177], v230 offset:28672
    ds_read_b64_tr_b16 v[178:179], v231 offset:29184
    ds_read_b64_tr_b16 v[180:181], v232 offset:28672
    ds_read_b64_tr_b16 v[182:183], v233 offset:29184
    s_waitcnt lgkmcnt(12)
    v_mfma_f32_16x16x32_bf16 v[184:187], v[148:151], v[152:155], v[184:187]
    v_mfma_f32_16x16x32_bf16 v[188:191], v[148:151], v[156:159], v[188:191]
    s_waitcnt lgkmcnt(6)
    v_mfma_f32_16x16x32_bf16 v[184:187], v[160:163], v[164:167], v[184:187]
    v_mfma_f32_16x16x32_bf16 v[188:191], v[160:163], v[168:171], v[188:191]
    s_waitcnt lgkmcnt(0)
    v_mfma_f32_16x16x32_bf16 v[184:187], v[172:175], v[176:179], v[184:187]
    v_mfma_f32_16x16x32_bf16 v[188:191], v[172:175], v[180:183], v[188:191]
    v_mov_b32 v194, s72
    v_mov_b32 v195, s73
    v_mov_b32_e64 v198, s72
    v_mov_b32 v199, s73
    s_nop 3
    v_cvt_pk_bf16_f32 v192, v184, v185
    v_cvt_pk_bf16_f32 v193, v186, v187
    buffer_store_dwordx4 v[192:195], v234, s[12:15], s31 offen sc1
    v_cvt_pk_bf16_f32 v196, v188, v189
    v_cvt_pk_bf16_f32 v197, v190, v191
    buffer_store_dwordx4 v[196:199], v235, s[12:15], s31 offen sc1
L_A_nokv:
    s_barrier
    s_cmp_lt_u32 s3, 4
    s_cbranch_scc0 L_A_qh
    s_lshl_b32 s31, s21, 3
    s_mul_i32 s31, s31, 6912
    s_add_u32 s45, s31, 131072
    v_cmp_gt_u32 vcc, 164, v0
    s_mov_b32 s79, 0
    s_mov_b32 s76, 0
    s_mov_b64 s[74:75], vcc
    v_mfma_f32_16x16x32_bf16 v[116:119], v[30:33], v[80:83], 0
    v_mfma_f32_16x16x32_bf16 v[120:123], v[40:43], v[80:83], 0
    v_mfma_f32_16x16x32_bf16 v[124:127], v[50:53], v[80:83], 0
    v_mfma_f32_16x16x32_bf16 v[128:131], v[60:63], v[80:83], 0
    v_mfma_f32_16x16x32_bf16 v[132:135], v[70:73], v[80:83], 0
    v_mfma_f32_16x16x32_bf16 v[116:119], v[34:37], v[84:87], v[116:119]
    v_mfma_f32_16x16x32_bf16 v[120:123], v[44:47], v[84:87], v[120:123]
    v_mfma_f32_16x16x32_bf16 v[124:127], v[54:57], v[84:87], v[124:127]
    v_mfma_f32_16x16x32_bf16 v[128:131], v[64:67], v[84:87], v[128:131]
    v_mfma_f32_16x16x32_bf16 v[132:135], v[74:77], v[84:87], v[132:135]
    v_mfma_f32_16x16x16_bf16 v[116:119], v[38:39], v[88:89], v[116:119]
    v_mfma_f32_16x16x16_bf16 v[120:123], v[48:49], v[88:89], v[120:123]
    v_mfma_f32_16x16x16_bf16 v[124:127], v[58:59], v[88:89], v[124:127]
    v_mfma_f32_16x16x16_bf16 v[128:131], v[68:69], v[88:89], v[128:131]
    v_mfma_f32_16x16x16_bf16 v[132:135], v[78:79], v[88:89], v[132:135]
    s_nop 4
    v_max3_f32 v2, v116, v117, v118
    v_min3_f32 v3, v116, v117, v118
    v_max3_f32 v2, v2, v119, v120
    v_min3_f32 v3, v3, v119, v120
    v_max3_f32 v2, v2, v121, v122
    v_min3_f32 v3, v3, v121, v122
    v_max3_f32 v2, v2, v123, v124
    v_min3_f32 v3, v3, v123, v124
    v_max3_f32 v2, v2, v125, v126
    v_min3_f32 v3, v3, v125, v126
    v_max3_f32 v2, v2, v127, v128
    v_min3_f32 v3, v3, v127, v128
    v_max3_f32 v2, v2, v129, v130
    v_min3_f32 v3, v3, v129, v130
    v_max3_f32 v2, v2, v131, v132
    v_min3_f32 v3, v3, v131, v132
    v_max3_f32 v2, v2, v133, v134
    v_min3_f32 v3, v3, v133, v134
    v_max_f32 v2, v2, v135
    v_min_f32 v3, v3, v135
    v_mul_f32 v2, s78, v2
    v_mul_f32 v3, s78, v3
    v_fma_f32 v148, v116, s78, -v2
    v_fma_f32 v180, -v116, s78, v3
    v_fma_f32 v149, v117, s78, -v2
    v_fma_f32 v181, -v117, s78, v3
    v_fma_f32 v150, v118, s78, -v2
    v_fma_f32 v182, -v118, s78, v3
    v_fma_f32 v151, v119, s78, -v2
    v_fma_f32 v183, -v119, s78, v3
    v_fma_f32 v152, v120, s78, -v2
    v_fma_f32 v184, -v120, s78, v3
    v_fma_f32 v153, v121, s78, -v2
    v_fma_f32 v185, -v121, s78, v3
    v_fma_f32 v154, v122, s78, -v2
    v_fma_f32 v186, -v122, s78, v3
    v_fma_f32 v155, v123, s78, -v2
    v_fma_f32 v187, -v123, s78, v3
    v_fma_f32 v156, v124, s78, -v2
    v_fma_f32 v188, -v124, s78, v3
    v_fma_f32 v157, v125, s78, -v2
    v_fma_f32 v189, -v125, s78, v3
    v_fma_f32 v158, v126, s78, -v2
    v_fma_f32 v190, -v126, s78, v3
    v_fma_f32 v159, v127, s78, -v2
    v_fma_f32 v191, -v127, s78, v3
    v_fma_f32 v160, v128, s78, -v2
    v_fma_f32 v192, -v128, s78, v3
    v_fma_f32 v161, v129, s78, -v2
    v_fma_f32 v193, -v129, s78, v3
    v_fma_f32 v162, v130, s78, -v2
    v_fma_f32 v194, -v130, s78, v3
    v_fma_f32 v163, v131, s78, -v2
    v_fma_f32 v195, -v131, s78, v3
    v_fma_f32 v164, v132, s78, -v2
    v_fma_f32 v196, -v132, s78, v3
    v_fma_f32 v165, v133, s78, -v2
    v_fma_f32 v197, -v133, s78, v3
    v_fma_f32 v166, v134, s78, -v2
    v_fma_f32 v198, -v134, s78, v3
    v_fma_f32 v167, v135, s78, -v2
    v_fma_f32 v199, -v135, s78, v3
    v_exp_f32 v148, v148
    v_exp_f32 v149, v149
    v_exp_f32 v150, v150
    v_exp_f32 v151, v151
    v_exp_f32 v152, v152
    v_exp_f32 v153, v153
    v_exp_f32 v154, v154
    v_exp_f32 v155, v155
    v_exp_f32 v156, v156
    v_exp_f32 v157, v157
    v_exp_f32 v158, v158
    v_exp_f32 v159, v159
    v_exp_f32 v160, v160
    v_exp_f32 v161, v161
    v_exp_f32 v162, v162
    v_exp_f32 v163, v163
    v_exp_f32 v164, v164
    v_exp_f32 v165, v165
    v_exp_f32 v166, v166
    v_exp_f32 v167, v167
    v_exp_f32 v180, v180
    v_exp_f32 v181, v181
    v_exp_f32 v182, v182
    v_exp_f32 v183, v183
    v_exp_f32 v184, v184
    v_exp_f32 v185, v185
    v_exp_f32 v186, v186
    v_exp_f32 v187, v187
    v_exp_f32 v188, v188
    v_exp_f32 v189, v189
    v_exp_f32 v190, v190
    v_exp_f32 v191, v191
    v_exp_f32 v192, v192
    v_exp_f32 v193, v193
    v_exp_f32 v194, v194
    v_exp_f32 v195, v195
    v_exp_f32 v196, v196
    v_exp_f32 v197, v197
    v_exp_f32 v198, v198
    v_exp_f32 v199, v199
    v_add_f32 v4, v148, v149
    v_add_f32 v5, v150, v151
    v_add_f32 v6, v180, v181
    v_add_f32 v7, v182, v183
    v_add_f32 v4, v4, v152
    v_add_f32 v5, v5, v153
    v_add_f32 v6, v6, v184
    v_add_f32 v7, v7, v185
    v_add_f32 v4, v4, v154
    v_add_f32 v5, v5, v155
    v_add_f32 v6, v6, v186
    v_add_f32 v7, v7, v187
    v_add_f32 v4, v4, v156
    v_add_f32 v5, v5, v157
    v_add_f32 v6, v6, v188
    v_add_f32 v7, v7, v189
    v_add_f32 v4, v4, v158
    v_add_f32 v5, v5, v159
    v_add_f32 v6, v6, v190
    v_add_f32 v7, v7, v191
    v_add_f32 v4, v4, v160
    v_add_f32 v5, v5, v161
    v_add_f32 v6, v6, v192
    v_add_f32 v7, v7, v193
    v_add_f32 v4, v4, v162
    v_add_f32 v5, v5, v163
    v_add_f32 v6, v6, v194
    v_add_f32 v7, v7, v195
    v_add_f32 v4, v4, v164
    v_add_f32 v5, v5, v165
    v_add_f32 v6, v6, v196
    v_add_f32 v7, v7, v197
    v_add_f32 v4, v4, v166
    v_add_f32 v5, v5, v167
    v_add_f32 v6, v6, v198
    v_add_f32 v7, v7, v199
    v_add_f32 v4, v4, v5
    v_add_f32 v6, v6, v7
    v_rcp_f32 v4, v4
    v_rcp_f32 v6, v6
    s_nop 0
    v_mul_f32 v148, v148, v4
    v_mul_f32 v149, v149, v4
    v_mul_f32 v150, v150, v4
    v_mul_f32 v151, v151, v4
    v_mul_f32 v152, v152, v4
    v_mul_f32 v153, v153, v4
    v_mul_f32 v154, v154, v4
    v_mul_f32 v155, v155, v4
    v_mul_f32 v156, v156, v4
    v_mul_f32 v157, v157, v4
    v_mul_f32 v158, v158, v4
    v_mul_f32 v159, v159, v4
    v_mul_f32 v160, v160, v4
    v_mul_f32 v161, v161, v4
    v_mul_f32 v162, v162, v4
    v_mul_f32 v163, v163, v4
    v_mul_f32 v164, v164, v4
    v_mul_f32 v165, v165, v4
    v_mul_f32 v166, v166, v4
    v_mul_f32 v167, v167, v4
    v_mul_f32 v180, v180, v6
    v_mul_f32 v181, v181, v6
    v_mul_f32 v182, v182, v6
    v_mul_f32 v183, v183, v6
    v_mul_f32 v184, v184, v6
    v_mul_f32 v185, v185, v6
    v_mul_f32 v186, v186, v6
    v_mul_f32 v187, v187, v6
    v_mul_f32 v188, v188, v6
    v_mul_f32 v189, v189, v6
    v_mul_f32 v190, v190, v6
    v_mul_f32 v191, v191, v6
    v_mul_f32 v192, v192, v6
    v_mul_f32 v193, v193, v6
    v_mul_f32 v194, v194, v6
    v_mul_f32 v195, v195, v6
    v_mul_f32 v196, v196, v6
    v_mul_f32 v197, v197, v6
    v_mul_f32 v198, v198, v6
    v_mul_f32_e64 v199, v199, v6
    v_cvt_pk_bf16_f32 v116, v148, v149
    v_cvt_pk_bf16_f32 v117, v150, v151
    v_cvt_pk_bf16_f32 v118, v152, v153
    v_cvt_pk_bf16_f32 v119, v154, v155
    v_cvt_pk_bf16_f32 v120, v156, v157
    v_cvt_pk_bf16_f32 v121, v158, v159
    v_cvt_pk_bf16_f32 v122, v160, v161
    v_cvt_pk_bf16_f32 v123, v162, v163
    v_cvt_pk_bf16_f32 v124, v164, v165
    v_cvt_pk_bf16_f32 v125, v166, v167
    v_cvt_pk_bf16_f32 v126, v180, v181
    v_cvt_pk_bf16_f32 v127, v182, v183
    v_cvt_pk_bf16_f32 v128, v184, v185
    v_cvt_pk_bf16_f32 v129, v186, v187
    v_cvt_pk_bf16_f32 v130, v188, v189
    v_cvt_pk_bf16_f32 v131, v190, v191
    v_cvt_pk_bf16_f32 v132, v192, v193
    v_cvt_pk_bf16_f32 v133, v194, v195
    v_cvt_pk_bf16_f32 v134, v196, v197
    v_cvt_pk_bf16_f32 v135, v198, v199
    s_nop 1
    v_permlane32_swap_b32 v116, v126
    v_permlane32_swap_b32 v117, v127
    v_permlane32_swap_b32 v118, v128
    v_permlane32_swap_b32 v119, v129
    v_permlane32_swap_b32 v120, v130
    v_permlane32_swap_b32 v121, v131
    v_permlane32_swap_b32 v122, v132
    v_permlane32_swap_b32 v123, v133
    v_permlane32_swap_b32 v124, v134
    v_permlane32_swap_b32 v125, v135
L_A_gather:
    s_bitcmp1_b32 s76, 0
    s_cbranch_scc1 L_g_12
    s_add_u32 s69, s45, 0
    buffer_load_dwordx4 v[100:103], v236, s[12:15], s69 offen sc0 sc1
    buffer_load_dwordx4 v[104:107], v237, s[12:15], s69 offen sc0 sc1
L_g_12:
    s_bitcmp1_b32 s76, 1
    s_cbranch_scc1 L_g_13
    s_add_u32 s69, s45, 6912
    buffer_load_dwordx4 v[108:111], v236, s[12:15], s69 offen sc0 sc1
    buffer_load_dwordx4 v[112:115], v237, s[12:15], s69 offen sc0 sc1
L_g_13:
    s_bitcmp1_b32 s76, 2
    s_cbranch_scc1 L_g_14
    s_add_u32 s69, s45, 13824
    buffer_load_dwordx4 v[136:139], v236, s[12:15], s69 offen sc0 sc1
    buffer_load_dwordx4 v[140:143], v237, s[12:15], s69 offen sc0 sc1
L_g_14:
    s_bitcmp1_b32 s76, 3
    s_cbranch_scc1 L_g_15
    s_add_u32 s69, s45, 20736
    buffer_load_dwordx4 v[144:147], v236, s[12:15], s69 offen sc0 sc1
    buffer_load_dwordx4 v[168:171], v237, s[12:15], s69 offen sc0 sc1
L_g_15:
    s_bitcmp1_b32 s76, 4
    s_cbranch_scc1 L_g_16
    s_add_u32 s69, s45, 27648
    buffer_load_dwordx4 v[172:175], v236, s[12:15], s69 offen sc0 sc1
    buffer_load_dwordx4 v[176:179], v237, s[12:15], s69 offen sc0 sc1
L_g_16:
    s_bitcmp1_b32 s76, 5
    s_cbranch_scc1 L_g_17
    s_add_u32 s69, s45, 34560
    buffer_load_dwordx4 v[200:203], v236, s[12:15], s69 offen sc0 sc1
    buffer_load_dwordx4 v[204:207], v237, s[12:15], s69 offen sc0 sc1
L_g_17:
    s_bitcmp1_b32 s76, 6
    s_cbranch_scc1 L_g_18
    s_add_u32 s69, s45, 41472
    buffer_load_dwordx4 v[208:211], v236, s[12:15], s69 offen sc0 sc1
    buffer_load_dwordx4 v[212:215], v237, s[12:15], s69 offen sc0 sc1
L_g_18:
    s_bitcmp1_b32 s76, 7
    s_cbranch_scc1 L_g_19
    s_add_u32 s69, s45, 48384
    buffer_load_dwordx4 v[216:219], v236, s[12:15], s69 offen sc0 sc1
    buffer_load_dwordx4 v[90:93], v237, s[12:15], s69 offen sc0 sc1
L_g_19:
L_A_gchk:
    s_waitcnt vmcnt(0)
    v_cmp_ne_u64 vcc, s[72:73], v[102:103]
    v_cmp_ne_u64 s[68:69], s[72:73], v[106:107]
    s_and_b64 s[68:69], s[68:69], s[74:75]
    s_or_b64 s[68:69], s[68:69], vcc
    s_cselect_b32 s77, 0, 1
    s_or_b32 s76, s76, s77
    v_cmp_ne_u64 vcc, s[72:73], v[110:111]
    v_cmp_ne_u64 s[68:69], s[72:73], v[114:115]
    s_and_b64 s[68:69], s[68:69], s[74:75]
    s_or_b64 s[68:69], s[68:69], vcc
    s_cselect_b32 s77, 0, 2
    s_or_b32 s76, s76, s77
    v_cmp_ne_u64 vcc, s[72:73], v[138:139]
    v_cmp_ne_u64 s[68:69], s[72:73], v[142:143]
    s_and_b64 s[68:69], s[68:69], s[74:75]
    s_or_b64 s[68:69], s[68:69], vcc
    s_cselect_b32 s77, 0, 4
    s_or_b32 s76, s76, s77
    v_cmp_ne_u64 vcc, s[72:73], v[146:147]
    v_cmp_ne_u64 s[68:69], s[72:73], v[170:171]
    s_and_b64 s[68:69], s[68:69], s[74:75]
    s_or_b64 s[68:69], s[68:69], vcc
    s_cselect_b32 s77, 0, 8
    s_or_b32 s76, s76, s77
    v_cmp_ne_u64 vcc, s[72:73], v[174:175]
    v_cmp_ne_u64 s[68:69], s[72:73], v[178:179]
    s_and_b64 s[68:69], s[68:69], s[74:75]
    s_or_b64 s[68:69], s[68:69], vcc
    s_cselect_b32 s77, 0, 16
    s_or_b32 s76, s76, s77
    v_cmp_ne_u64 vcc, s[72:73], v[202:203]
    v_cmp_ne_u64 s[68:69], s[72:73], v[206:207]
    s_and_b64 s[68:69], s[68:69], s[74:75]
    s_or_b64 s[68:69], s[68:69], vcc
    s_cselect_b32 s77, 0, 32
    s_or_b32 s76, s76, s77
    v_cmp_ne_u64 vcc, s[72:73], v[210:211]
    v_cmp_ne_u64 s[68:69], s[72:73], v[214:215]
    s_and_b64 s[68:69], s[68:69], s[74:75]
    s_or_b64 s[68:69], s[68:69], vcc
    s_cselect_b32 s77, 0, 64
    s_or_b32 s76, s76, s77
    v_cmp_ne_u64 vcc, s[72:73], v[218:219]
    v_cmp_ne_u64 s[68:69], s[72:73], v[92:93]
    s_and_b64 s[68:69], s[68:69], s[74:75]
    s_or_b64 s[68:69], s[68:69], vcc
    s_cselect_b32 s77, 0, 128
    s_or_b32 s76, s76, s77
    s_cmp_eq_u32 s76, 255
    s_cbranch_scc1 L_A_gok
    s_add_u32 s79, s79, 1
    s_cmp_lt_u32 s79, 0x8000
    s_cbranch_scc1 L_A_gather
L_A_gok:
    v_lshlrev_b32 v4, 16, v100
    v_and_b32 v5, 0xffff0000, v100
    v_lshlrev_b32_e64 v6, 16, v101
    v_and_b32 v7, 0xffff0000, v101
    v_lshlrev_b32_e64 v8, 16, v104
    v_and_b32 v9, 0xffff0000, v104
    v_lshlrev_b32_e64 v10, 16, v105
    v_and_b32 v11, 0xffff0000, v105
    v_lshlrev_b32 v12, 16, v108
    v_add_f32 v4, v4, v12
    v_and_b32 v13, 0xffff0000, v108
    v_add_f32 v5, v5, v13
    v_lshlrev_b32 v12, 16, v109
    v_add_f32_e64 v6, v6, v12
    v_and_b32 v13, 0xffff0000, v109
    v_add_f32 v7, v7, v13
    v_lshlrev_b32 v12, 16, v112
    v_add_f32_e64 v8, v8, v12
    v_and_b32 v13, 0xffff0000, v112
    v_add_f32 v9, v9, v13
    v_lshlrev_b32 v12, 16, v113
    v_add_f32_e64 v10, v10, v12
    v_and_b32 v13, 0xffff0000, v113
    v_add_f32 v11, v11, v13
    v_lshlrev_b32 v12, 16, v136
    v_add_f32_e64 v4, v4, v12
    v_and_b32 v13, 0xffff0000, v136
    v_add_f32 v5, v5, v13
    v_lshlrev_b32 v12, 16, v137
    v_add_f32_e64 v6, v6, v12
    v_and_b32 v13, 0xffff0000, v137
    v_add_f32 v7, v7, v13
    v_lshlrev_b32 v12, 16, v140
    v_add_f32_e64 v8, v8, v12
    v_and_b32 v13, 0xffff0000, v140
    v_add_f32 v9, v9, v13
    v_lshlrev_b32 v12, 16, v141
    v_add_f32_e64 v10, v10, v12
    v_and_b32 v13, 0xffff0000, v141
    v_add_f32 v11, v11, v13
    v_lshlrev_b32 v12, 16, v144
    v_add_f32_e64 v4, v4, v12
    v_and_b32 v13, 0xffff0000, v144
    v_add_f32 v5, v5, v13
    v_lshlrev_b32 v12, 16, v145
    v_add_f32_e64 v6, v6, v12
    v_and_b32 v13, 0xffff0000, v145
    v_add_f32 v7, v7, v13
    v_lshlrev_b32 v12, 16, v168
    v_add_f32_e64 v8, v8, v12
    v_and_b32 v13, 0xffff0000, v168
    v_add_f32 v9, v9, v13
    v_lshlrev_b32 v12, 16, v169
    v_add_f32_e64 v10, v10, v12
    v_and_b32 v13, 0xffff0000, v169
    v_add_f32 v11, v11, v13
    v_lshlrev_b32 v12, 16, v172
    v_add_f32_e64 v4, v4, v12
    v_and_b32 v13, 0xffff0000, v172
    v_add_f32 v5, v5, v13
    v_lshlrev_b32 v12, 16, v173
    v_add_f32_e64 v6, v6, v12
    v_and_b32 v13, 0xffff0000, v173
    v_add_f32 v7, v7, v13
    v_lshlrev_b32 v12, 16, v176
    v_add_f32_e64 v8, v8, v12
    v_and_b32 v13, 0xffff0000, v176
    v_add_f32 v9, v9, v13
    v_lshlrev_b32 v12, 16, v177
    v_add_f32_e64 v10, v10, v12
    v_and_b32 v13, 0xffff0000, v177
    v_add_f32 v11, v11, v13
    v_lshlrev_b32 v12, 16, v200
    v_add_f32_e64 v4, v4, v12
    v_and_b32 v13, 0xffff0000, v200
    v_add_f32 v5, v5, v13
    v_lshlrev_b32 v12, 16, v201
    v_add_f32_e64 v6, v6, v12
    v_and_b32 v13, 0xffff0000, v201
    v_add_f32 v7, v7, v13
    v_lshlrev_b32 v12, 16, v204
    v_add_f32_e64 v8, v8, v12
    v_and_b32 v13, 0xffff0000, v204
    v_add_f32 v9, v9, v13
    v_lshlrev_b32 v12, 16, v205
    v_add_f32_e64 v10, v10, v12
    v_and_b32 v13, 0xffff0000, v205
    v_add_f32 v11, v11, v13
    v_lshlrev_b32 v12, 16, v208
    v_add_f32_e64 v4, v4, v12
    v_and_b32 v13, 0xffff0000, v208
    v_add_f32 v5, v5, v13
    v_lshlrev_b32 v12, 16, v209
    v_add_f32_e64 v6, v6, v12
    v_and_b32 v13, 0xffff0000, v209
    v_add_f32 v7, v7, v13
    v_lshlrev_b32 v12, 16, v212
    v_add_f32_e64 v8, v8, v12
    v_and_b32 v13, 0xffff0000, v212
    v_add_f32 v9, v9, v13
    v_lshlrev_b32 v12, 16, v213
    v_add_f32_e64 v10, v10, v12
    v_and_b32 v13, 0xffff0000, v213
    v_add_f32 v11, v11, v13
    v_lshlrev_b32 v12, 16, v216
    v_add_f32_e64 v4, v4, v12
    v_and_b32 v13, 0xffff0000, v216
    v_add_f32 v5, v5, v13
    v_lshlrev_b32 v12, 16, v217
    v_add_f32_e64 v6, v6, v12
    v_and_b32 v13, 0xffff0000, v217
    v_add_f32 v7, v7, v13
    v_lshlrev_b32 v12, 16, v90
    v_add_f32_e64 v8, v8, v12
    v_and_b32 v13, 0xffff0000, v90
    v_add_f32 v9, v9, v13
    v_lshlrev_b32 v12, 16, v91
    v_add_f32_e64 v10, v10, v12
    v_and_b32 v13, 0xffff0000, v91
    v_add_f32_e64 v11, v11, v13
    v_cvt_pk_bf16_f32 v4, v4, v5
    v_cvt_pk_bf16_f32 v5, v6, v7
    v_cvt_pk_bf16_f32 v8, v8, v9
    v_cvt_pk_bf16_f32 v9, v10, v11
    ds_write_b64 v238, v[4:5]
    s_mov_b64 exec, s[74:75]
    ds_write_b64 v239, v[8:9]
    s_mov_b64 exec, -1
    s_branch L_A_gdone
L_A_qh:
    s_mov_b32 s8, s38
    s_mov_b32 s9, s39
    s_mov_b32 s10, 819200
    s_lshr_b32 s31, s30, 2
    s_mul_i32 s31, s31, 160
    s_mul_i32 s69, s67, 204800
    s_add_u32 s31, s31, s69
    s_mul_i32 s68, s67, 25600
    v_mfma_f32_16x16x32_bf16 v[116:119], v[30:33], v[80:83], 0
    v_mfma_f32_16x16x32_bf16 v[120:123], v[40:43], v[80:83], 0
    v_mfma_f32_16x16x32_bf16 v[124:127], v[50:53], v[80:83], 0
    v_mfma_f32_16x16x32_bf16 v[128:131], v[60:63], v[80:83], 0
    v_mfma_f32_16x16x32_bf16 v[132:135], v[70:73], v[80:83], 0
    v_mfma_f32_16x16x32_bf16 v[116:119], v[34:37], v[84:87], v[116:119]
    v_mfma_f32_16x16x32_bf16 v[120:123], v[44:47], v[84:87], v[120:123]
    v_mfma_f32_16x16x32_bf16 v[124:127], v[54:57], v[84:87], v[124:127]
    v_mfma_f32_16x16x32_bf16 v[128:131], v[64:67], v[84:87], v[128:131]
    v_mfma_f32_16x16x32_bf16 v[132:135], v[74:77], v[84:87], v[132:135]
    v_mfma_f32_16x16x16_bf16 v[116:119], v[38:39], v[88:89], v[116:119]
    v_mfma_f32_16x16x16_bf16 v[120:123], v[48:49], v[88:89], v[120:123]
    v_mfma_f32_16x16x16_bf16 v[124:127], v[58:59], v[88:89], v[124:127]
    v_mfma_f32_16x16x16_bf16 v[128:131], v[68:69], v[88:89], v[128:131]
    v_mfma_f32_16x16x16_bf16 v[132:135], v[78:79], v[88:89], v[132:135]
    s_nop 4
    v_max3_f32 v2, v116, v117, v118
    v_min3_f32 v3, v116, v117, v118
    v_max3_f32 v2, v2, v119, v120
    v_min3_f32 v3, v3, v119, v120
    v_max3_f32 v2, v2, v121, v122
    v_min3_f32 v3, v3, v121, v122
    v_max3_f32 v2, v2, v123, v124
    s_add_u32 m0, s68, 0
    s_nop 0
    buffer_load_dwordx4 v100, s[8:11], s31 offen lds
    v_min3_f32 v3, v3, v123, v124
    v_max3_f32 v2, v2, v125, v126
    v_min3_f32 v3, v3, v125, v126
    v_max3_f32 v2, v2, v127, v128
    v_min3_f32 v3, v3, v127, v128
    v_max3_f32 v2, v2, v129, v130
    v_min3_f32 v3, v3, v129, v130
    s_add_u32 m0, s68, 1024
    s_nop 0
    buffer_load_dwordx4 v101, s[8:11], s31 offen lds
    v_max3_f32 v2, v2, v131, v132
    v_min3_f32 v3, v3, v131, v132
    v_max3_f32 v2, v2, v133, v134
    v_min3_f32 v3, v3, v133, v134
    v_max_f32 v2, v2, v135
    v_min_f32 v3, v3, v135
    v_mul_f32 v2, s78, v2
    s_add_u32 m0, s68, 2048
    s_nop 0
    buffer_load_dwordx4 v102, s[8:11], s31 offen lds
    v_mul_f32 v3, s78, v3
    v_fma_f32 v148, v116, s78, -v2
    v_fma_f32 v180, -v116, s78, v3
    v_fma_f32 v149, v117, s78, -v2
    v_fma_f32 v181, -v117, s78, v3
    v_fma_f32 v150, v118, s78, -v2
    v_fma_f32 v182, -v118, s78, v3
    s_add_u32 m0, s68, 3072
    s_nop 0
    buffer_load_dwordx4 v103, s[8:11], s31 offen lds
    v_fma_f32 v151, v119, s78, -v2
    v_fma_f32 v183, -v119, s78, v3
    v_fma_f32 v152, v120, s78, -v2
    v_fma_f32 v184, -v120, s78, v3
    v_fma_f32 v153, v121, s78, -v2
    v_fma_f32 v185, -v121, s78, v3
    v_fma_f32 v154, v122, s78, -v2
    s_add_u32 m0, s68, 4096
    s_nop 0
    buffer_load_dwordx4 v104, s[8:11], s31 offen lds
    s_add_u32 s31, s31, 40960
    v_fma_f32 v186, -v122, s78, v3
    v_fma_f32 v155, v123, s78, -v2
    v_fma_f32 v187, -v123, s78, v3
    v_fma_f32 v156, v124, s78, -v2
    v_fma_f32 v188, -v124, s78, v3
    v_fma_f32 v157, v125, s78, -v2
    v_fma_f32 v189, -v125, s78, v3
    s_add_u32 m0, s68, 5120
    s_nop 0
    buffer_load_dwordx4 v100, s[8:11], s31 offen lds
    v_fma_f32 v158, v126, s78, -v2
    v_fma_f32 v190, -v126, s78, v3
    v_fma_f32 v159, v127, s78, -v2
    v_fma_f32 v191, -v127, s78, v3
    v_fma_f32 v160, v128, s78, -v2
    v_fma_f32 v192, -v128, s78, v3
    v_fma_f32 v161, v129, s78, -v2
    s_add_u32 m0, s68, 6144
    s_nop 0
    buffer_load_dwordx4 v101, s[8:11], s31 offen lds
    v_fma_f32 v193, -v129, s78, v3
    v_fma_f32 v162, v130, s78, -v2
    v_fma_f32 v194, -v130, s78, v3
    v_fma_f32 v163, v131, s78, -v2
    v_fma_f32 v195, -v131, s78, v3
    v_fma_f32 v164, v132, s78, -v2
    v_fma_f32 v196, -v132, s78, v3
    s_add_u32 m0, s68, 7168
    s_nop 0
    buffer_load_dwordx4 v102, s[8:11], s31 offen lds
    v_fma_f32 v165, v133, s78, -v2
    v_fma_f32 v197, -v133, s78, v3
    v_fma_f32 v166, v134, s78, -v2
    v_fma_f32 v198, -v134, s78, v3
    v_fma_f32 v167, v135, s78, -v2
    v_fma_f32 v199, -v135, s78, v3
    v_exp_f32 v148, v148
    s_add_u32 m0, s68, 8192
    s_nop 0
    buffer_load_dwordx4 v103, s[8:11], s31 offen lds
    v_exp_f32 v149, v149
    v_exp_f32 v150, v150
    v_exp_f32 v151, v151
    v_exp_f32 v152, v152
    v_exp_f32 v153, v153
    v_exp_f32 v154, v154
    v_exp_f32 v155, v155
    s_add_u32 m0, s68, 9216
    s_nop 0
    buffer_load_dwordx4 v104, s[8:11], s31 offen lds
    s_add_u32 s31, s31, 40960
    v_exp_f32 v156, v156
    v_exp_f32 v157, v157
    v_exp_f32 v158, v158
    v_exp_f32 v159, v159
    v_exp_f32 v160, v160
    v_exp_f32 v161, v161
    v_exp_f32 v162, v162
    s_add_u32 m0, s68, 10240
    s_nop 0
    buffer_load_dwordx4 v100, s[8:11], s31 offen lds
    v_exp_f32 v163, v163
    v_exp_f32 v164, v164
    v_exp_f32 v165, v165
    v_exp_f32 v166, v166
    v_exp_f32 v167, v167
    v_exp_f32 v180, v180
    v_exp_f32 v181, v181
    s_add_u32 m0, s68, 11264
    s_nop 0
    buffer_load_dwordx4 v101, s[8:11], s31 offen lds
    v_exp_f32 v182, v182
    v_exp_f32 v183, v183
    v_exp_f32 v184, v184
    v_exp_f32 v185, v185
    v_exp_f32 v186, v186
    v_exp_f32 v187, v187
    v_exp_f32 v188, v188
    s_add_u32 m0, s68, 12288
    s_nop 0
    buffer_load_dwordx4 v102, s[8:11], s31 offen lds
    v_exp_f32 v189, v189
    v_exp_f32 v190, v190
    v_exp_f32 v191, v191
    v_exp_f32 v192, v192
    v_exp_f32 v193, v193
    v_exp_f32 v194, v194
    v_exp_f32 v195, v195
    s_add_u32 m0, s68, 13312
    s_nop 0
    buffer_load_dwordx4 v103, s[8:11], s31 offen lds
    v_exp_f32 v196, v196
    v_exp_f32 v197, v197
    v_exp_f32 v198, v198
    v_exp_f32 v199, v199
    v_add_f32 v4, v148, v149
    v_add_f32 v5, v150, v151
    v_add_f32 v6, v180, v181
    s_add_u32 m0, s68, 14336
    s_nop 0
    buffer_load_dwordx4 v104, s[8:11], s31 offen lds
    s_add_u32 s31, s31, 40960
    v_add_f32 v7, v182, v183
    v_add_f32 v4, v4, v152
    v_add_f32 v5, v5, v153
    v_add_f32 v6, v6, v184
    v_add_f32 v7, v7, v185
    v_add_f32 v4, v4, v154
    v_add_f32 v5, v5, v155
    s_add_u32 m0, s68, 15360
    s_nop 0
    buffer_load_dwordx4 v100, s[8:11], s31 offen lds
    v_add_f32 v6, v6, v186
    v_add_f32 v7, v7, v187
    v_add_f32 v4, v4, v156
    v_add_f32 v5, v5, v157
    v_add_f32 v6, v6, v188
    v_add_f32 v7, v7, v189
    v_add_f32 v4, v4, v158
    s_add_u32 m0, s68, 16384
    s_nop 0
    buffer_load_dwordx4 v101, s[8:11], s31 offen lds
    v_add_f32 v5, v5, v159
    v_add_f32 v6, v6, v190
    v_add_f32 v7, v7, v191
    v_add_f32 v4, v4, v160
    v_add_f32 v5, v5, v161
    v_add_f32 v6, v6, v192
    v_add_f32 v7, v7, v193
    s_add_u32 m0, s68, 17408
    s_nop 0
    buffer_load_dwordx4 v102, s[8:11], s31 offen lds
    v_add_f32 v4, v4, v162
    v_add_f32 v5, v5, v163
    v_add_f32 v6, v6, v194
    v_add_f32 v7, v7, v195
    v_add_f32 v4, v4, v164
    v_add_f32 v5, v5, v165
    v_add_f32 v6, v6, v196
    s_add_u32 m0, s68, 18432
    s_nop 0
    buffer_load_dwordx4 v103, s[8:11], s31 offen lds
    v_add_f32 v7, v7, v197
    v_add_f32 v4, v4, v166
    v_add_f32 v5, v5, v167
    v_add_f32 v6, v6, v198
    v_add_f32 v7, v7, v199
    v_add_f32 v4, v4, v5
    v_add_f32 v6, v6, v7
    s_add_u32 m0, s68, 19456
    s_nop 0
    buffer_load_dwordx4 v104, s[8:11], s31 offen lds
    s_add_u32 s31, s31, 40960
    v_rcp_f32 v4, v4
    v_rcp_f32 v6, v6
    s_nop 0
    v_mul_f32 v148, v148, v4
    v_mul_f32 v149, v149, v4
    v_mul_f32 v150, v150, v4
    v_mul_f32 v151, v151, v4
    v_mul_f32_e64 v152, v152, v4
    s_add_u32 m0, s68, 20480
    s_nop 0
    buffer_load_dwordx4 v100, s[8:11], s31 offen lds
    v_mul_f32 v153, v153, v4
    v_mul_f32 v154, v154, v4
    v_mul_f32 v155, v155, v4
    v_mul_f32 v156, v156, v4
    v_mul_f32 v157, v157, v4
    v_mul_f32 v158, v158, v4
    v_mul_f32 v159, v159, v4
    s_add_u32 m0, s68, 21504
    s_nop 0
    buffer_load_dwordx4 v101, s[8:11], s31 offen lds
    v_mul_f32 v160, v160, v4
    v_mul_f32 v161, v161, v4
    v_mul_f32 v162, v162, v4
    v_mul_f32 v163, v163, v4
    v_mul_f32 v164, v164, v4
    v_mul_f32 v165, v165, v4
    v_mul_f32 v166, v166, v4
    s_add_u32 m0, s68, 22528
    s_nop 0
    buffer_load_dwordx4 v102, s[8:11], s31 offen lds
    v_mul_f32 v167, v167, v4
    v_mul_f32 v180, v180, v6
    v_mul_f32 v181, v181, v6
    v_mul_f32 v182, v182, v6
    v_mul_f32 v183, v183, v6
    v_mul_f32 v184, v184, v6
    v_mul_f32 v185, v185, v6
    s_add_u32 m0, s68, 23552
    s_nop 0
    buffer_load_dwordx4 v103, s[8:11], s31 offen lds
    v_mul_f32 v186, v186, v6
    v_mul_f32 v187, v187, v6
    v_mul_f32 v188, v188, v6
    v_mul_f32 v189, v189, v6
    v_mul_f32 v190, v190, v6
    v_mul_f32 v191, v191, v6
    v_mul_f32 v192, v192, v6
    s_add_u32 m0, s68, 24576
    s_nop 0
    buffer_load_dwordx4 v104, s[8:11], s31 offen lds
    s_add_u32 s31, s31, 40960
    v_mul_f32 v193, v193, v6
    v_mul_f32 v194, v194, v6
    v_mul_f32 v195, v195, v6
    v_mul_f32 v196, v196, v6
    v_mul_f32 v197, v197, v6
    v_mul_f32 v198, v198, v6
    v_mul_f32 v199, v199, v6
    v_cvt_pk_bf16_f32 v116, v148, v149
    v_cvt_pk_bf16_f32 v117, v150, v151
    v_cvt_pk_bf16_f32 v118, v152, v153
    v_cvt_pk_bf16_f32 v119, v154, v155
    v_cvt_pk_bf16_f32 v120, v156, v157
    v_cvt_pk_bf16_f32 v121, v158, v159
    v_cvt_pk_bf16_f32 v122, v160, v161
    v_cvt_pk_bf16_f32 v123, v162, v163
    v_cvt_pk_bf16_f32 v124, v164, v165
    v_cvt_pk_bf16_f32 v125, v166, v167
    v_cvt_pk_bf16_f32 v126, v180, v181
    v_cvt_pk_bf16_f32 v127, v182, v183
    v_cvt_pk_bf16_f32 v128, v184, v185
    v_cvt_pk_bf16_f32 v129, v186, v187
    v_cvt_pk_bf16_f32 v130, v188, v189
    v_cvt_pk_bf16_f32 v131, v190, v191
    v_cvt_pk_bf16_f32 v132, v192, v193
    v_cvt_pk_bf16_f32 v133, v194, v195
    v_cvt_pk_bf16_f32 v134, v196, v197
    v_cvt_pk_bf16_f32 v135, v198, v199
    s_nop 1
    v_permlane32_swap_b32 v116, v126
    v_permlane32_swap_b32 v117, v127
    v_permlane32_swap_b32 v118, v128
    v_permlane32_swap_b32 v119, v129
    v_permlane32_swap_b32 v120, v130
    v_permlane32_swap_b32 v121, v131
    v_permlane32_swap_b32 v122, v132
    v_permlane32_swap_b32 v123, v133
    v_permlane32_swap_b32 v124, v134
    v_permlane32_swap_b32 v125, v135
    v_add_u32 v220, 73728, v220
    ds_write_b128 v220, v[116:119] offset:0
    ds_write_b128 v220, v[120:123] offset:1024
    ds_write_b128 v220, v[124:127] offset:2048
    ds_write_b128 v220, v[128:131] offset:3072
    ds_write_b128 v220, v[132:135] offset:4096
    s_waitcnt lgkmcnt(0)
    s_barrier
    s_branch L_A_phase2
L_A_gdone:
    s_lshl_b32 s31, s20, 4
    s_lshl_b32 s69, s67, 2
    s_add_u32 s31, s31, s69
    s_mul_i32 s31, s31, 20480
    s_mul_i32 s69, s21, 1280
    s_add_u32 s31, s31, s69
    s_add_u32 s40, s31, 1048576
    s_add_u32 s41, s40, 20480
    s_add_u32 s42, s40, 40960
    s_add_u32 s43, s40, 61440
    s_lshl_b32 s31, s20, 1
    s_lshr_b32 s69, s3, 1
    s_add_u32 s31, s31, s69
    s_lshl_b32 s31, s31, 8
    s_lshl_b32 s69, s21, 4
    s_add_u32 s31, s31, s69
    s_and_b32 s69, s3, 1
    s_lshl_b32 s69, s69, 3
    s_add_u32 s31, s31, s69
    s_add_u32 s44, s31, 4096
    v_mov_b32 v14, 0
    v_mov_b32 v18, s72
    v_mov_b32 v19, s73
    v_add_u32 v220, 73728, v220
    s_waitcnt lgkmcnt(0)
    s_barrier
    ds_read_b128 v[34:37], v240
    ds_read_b128 v[38:41], v240 offset:16
    ds_read_b64 v[42:43], v240 offset:32
    ds_read_b128 v[44:47], v241
    ds_read_b128 v[48:51], v241 offset:16
    ds_read_b64 v[52:53], v241 offset:32
    ds_read_b128 v[54:57], v242
    ds_read_b128 v[58:61], v242 offset:16
    ds_read_b64 v[62:63], v242 offset:32
    ds_read_b128 v[96:99], v220 offset:0
    ds_read_b128 v[100:103], v220 offset:1024
    ds_read_b128 v[104:107], v220 offset:2048
    ds_read_b128 v[108:111], v220 offset:3072
    ds_read_b128 v[112:115], v220 offset:4096
    s_waitcnt lgkmcnt(5)
    v_mfma_f32_16x16x32_bf16 v[136:139], v[34:37], v[116:119], 0
    v_mfma_f32_16x16x32_bf16 v[140:143], v[44:47], v[116:119], 0
    v_mfma_f32_16x16x32_bf16 v[144:147], v[54:57], v[116:119], 0
    v_mfma_f32_16x16x32_bf16 v[136:139], v[38:41], v[120:123], v[136:139]
    v_mfma_f32_16x16x32_bf16 v[140:143], v[48:51], v[120:123], v[140:143]
    v_mfma_f32_16x16x32_bf16 v[144:147], v[58:61], v[120:123], v[144:147]
    v_mfma_f32_16x16x16_bf16 v[136:139], v[42:43], v[124:125], v[136:139]
    v_mfma_f32_16x16x16_bf16 v[140:143], v[52:53], v[124:125], v[140:143]
    v_mfma_f32_16x16x16_bf16 v[144:147], v[62:63], v[124:125], v[144:147]
    v_mfma_f32_16x16x32_bf16 v[148:151], v[34:37], v[126:129], 0
    v_mfma_f32_16x16x32_bf16 v[152:155], v[44:47], v[126:129], 0
    v_mfma_f32_16x16x32_bf16 v[156:159], v[54:57], v[126:129], 0
    v_mfma_f32_16x16x32_bf16 v[148:151], v[38:41], v[130:133], v[148:151]
    v_mfma_f32_16x16x32_bf16 v[152:155], v[48:51], v[130:133], v[152:155]
    v_mfma_f32_16x16x32_bf16 v[156:159], v[58:61], v[130:133], v[156:159]
    v_mfma_f32_16x16x16_bf16 v[148:151], v[42:43], v[134:135], v[148:151]
    v_mfma_f32_16x16x16_bf16 v[152:155], v[52:53], v[134:135], v[152:155]
    v_mfma_f32_16x16x16_bf16 v[156:159], v[62:63], v[134:135], v[156:159]
    s_waitcnt lgkmcnt(0)
    v_mfma_f32_16x16x32_bf16 v[160:163], v[34:37], v[96:99], 0
    v_mfma_f32_16x16x32_bf16 v[164:167], v[44:47], v[96:99], 0
    v_mfma_f32_16x16x32_bf16 v[168:171], v[54:57], v[96:99], 0
    v_mfma_f32_16x16x32_bf16 v[160:163], v[38:41], v[100:103], v[160:163]
    v_mfma_f32_16x16x32_bf16 v[164:167], v[48:51], v[100:103], v[164:167]
    v_mfma_f32_16x16x32_bf16 v[168:171], v[58:61], v[100:103], v[168:171]
    v_mfma_f32_16x16x16_bf16 v[160:163], v[42:43], v[104:105], v[160:163]
    v_mfma_f32_16x16x16_bf16 v[164:167], v[52:53], v[104:105], v[164:167]
    v_mfma_f32_16x16x16_bf16 v[168:171], v[62:63], v[104:105], v[168:171]
    v_mfma_f32_16x16x32_bf16 v[172:175], v[34:37], v[106:109], 0
    v_mfma_f32_16x16x32_bf16 v[176:179], v[44:47], v[106:109], 0
    v_mfma_f32_16x16x32_bf16 v[180:183], v[54:57], v[106:109], 0
    v_mfma_f32_16x16x32_bf16 v[172:175], v[38:41], v[110:113], v[172:175]
    v_mfma_f32_16x16x32_bf16 v[176:179], v[48:51], v[110:113], v[176:179]
    v_mfma_f32_16x16x32_bf16 v[180:183], v[58:61], v[110:113], v[180:183]
    v_mfma_f32_16x16x16_bf16 v[172:175], v[42:43], v[114:115], v[172:175]
    v_mfma_f32_16x16x16_bf16 v[176:179], v[52:53], v[114:115], v[176:179]
    v_mfma_f32_16x16x16_bf16 v[180:183], v[62:63], v[114:115], v[180:183]
    v_add_f32 v9, 0x358637bd, v146
    v_rcp_f32 v9, v9
    s_nop 0
    v_pk_mul_f32 v[136:137], v[136:137], v[8:9] op_sel:[0,1] op_sel_hi:[1,1]
    v_pk_mul_f32 v[138:139], v[138:139], v[8:9] op_sel:[0,1] op_sel_hi:[1,1]
    v_pk_mul_f32 v[140:141], v[140:141], v[8:9] op_sel:[0,1] op_sel_hi:[1,1]
    v_pk_mul_f32 v[142:143], v[142:143], v[8:9] op_sel:[0,1] op_sel_hi:[1,1]
    v_pk_mul_f32 v[144:145], v[144:145], v[8:9] op_sel:[0,1] op_sel_hi:[1,1]
    v_cvt_pk_bf16_f32 v136, v136, v137
    v_cvt_pk_bf16_f32 v137, v138, v139
    v_cvt_pk_bf16_f32 v138, v140, v141
    v_cvt_pk_bf16_f32 v139, v142, v143
    v_cvt_pk_bf16_f32 v140, v144, v145
    ds_write2_b32 v243, v136, v137 offset0:0 offset1:1
    ds_write2_b32 v243, v138, v139 offset0:2 offset1:3
    ds_write_b32 v243, v140 offset:16
    v_add_f32 v9, 0x358637bd, v158
    v_rcp_f32 v9, v9
    s_nop 0
    v_pk_mul_f32 v[148:149], v[148:149], v[8:9] op_sel:[0,1] op_sel_hi:[1,1]
    v_pk_mul_f32 v[150:151], v[150:151], v[8:9] op_sel:[0,1] op_sel_hi:[1,1]
    v_pk_mul_f32 v[152:153], v[152:153], v[8:9] op_sel:[0,1] op_sel_hi:[1,1]
    v_pk_mul_f32 v[154:155], v[154:155], v[8:9] op_sel:[0,1] op_sel_hi:[1,1]
    v_pk_mul_f32 v[156:157], v[156:157], v[8:9] op_sel:[0,1] op_sel_hi:[1,1]
    v_cvt_pk_bf16_f32 v148, v148, v149
    v_cvt_pk_bf16_f32 v149, v150, v151
    v_cvt_pk_bf16_f32 v150, v152, v153
    v_cvt_pk_bf16_f32 v151, v154, v155
    v_cvt_pk_bf16_f32 v152, v156, v157
    ds_write2_b32 v244, v148, v149 offset0:0 offset1:1
    ds_write2_b32 v244, v150, v151 offset0:2 offset1:3
    ds_write_b32 v244, v152 offset:16
    ds_read_b128 v[40:43], v245 offset:0
    ds_read_b128 v[44:47], v245 offset:1280
    ds_read_b128 v[48:51], v246 offset:64
    v_add_f32 v9, 0x358637bd, v170
    v_rcp_f32 v9, v9
    s_nop 0
    v_pk_mul_f32 v[160:161], v[160:161], v[8:9] op_sel:[0,1] op_sel_hi:[1,1]
    v_pk_mul_f32 v[162:163], v[162:163], v[8:9] op_sel:[0,1] op_sel_hi:[1,1]
    v_pk_mul_f32 v[164:165], v[164:165], v[8:9] op_sel:[0,1] op_sel_hi:[1,1]
    v_pk_mul_f32 v[166:167], v[166:167], v[8:9] op_sel:[0,1] op_sel_hi:[1,1]
    v_pk_mul_f32 v[168:169], v[168:169], v[8:9] op_sel:[0,1] op_sel_hi:[1,1]
    v_cvt_pk_bf16_f32 v160, v160, v161
    v_cvt_pk_bf16_f32 v161, v162, v163
    v_cvt_pk_bf16_f32 v162, v164, v165
    v_cvt_pk_bf16_f32 v163, v166, v167
    v_cvt_pk_bf16_f32 v164, v168, v169
    ds_write_b32 v243, v160 offset:2560
    ds_write_b32 v243, v161 offset:2564
    ds_write_b32 v243, v162 offset:2568
    ds_write_b32 v243, v163 offset:2572
    ds_write_b32 v243, v164 offset:2576
    s_nop 0
    v_add_f32 v9, 0x358637bd, v182
    v_rcp_f32 v9, v9
    s_nop 0
    v_pk_mul_f32 v[172:173], v[172:173], v[8:9] op_sel:[0,1] op_sel_hi:[1,1]
    v_pk_mul_f32 v[174:175], v[174:175], v[8:9] op_sel:[0,1] op_sel_hi:[1,1]
    v_pk_mul_f32 v[176:177], v[176:177], v[8:9] op_sel:[0,1] op_sel_hi:[1,1]
    v_pk_mul_f32 v[178:179], v[178:179], v[8:9] op_sel:[0,1] op_sel_hi:[1,1]
    v_pk_mul_f32 v[180:181], v[180:181], v[8:9] op_sel:[0,1] op_sel_hi:[1,1]
    v_cvt_pk_bf16_f32 v172, v172, v173
    v_cvt_pk_bf16_f32 v173, v174, v175
    v_cvt_pk_bf16_f32 v174, v176, v177
    v_cvt_pk_bf16_f32 v175, v178, v179
    v_cvt_pk_bf16_f32 v176, v180, v181
    ds_write_b32 v244, v172 offset:2560
    ds_write_b32 v244, v173 offset:2564
    ds_write_b32 v244, v174 offset:2568
    ds_write_b32 v244, v175 offset:2572
    ds_write_b32 v244, v176 offset:2576
    ds_read_b128 v[52:55], v245 offset:2560
    ds_read_b128 v[56:59], v245 offset:3840
    ds_read_b128 v[60:63], v246 offset:2624
    s_waitcnt lgkmcnt(13)
    buffer_store_dwordx4 v[40:43], v247, s[12:15], s40 offen sc1
    buffer_store_dwordx4 v[44:47], v247, s[12:15], s41 offen sc1
    s_mov_b64 exec, 0xffffffff
    buffer_store_dwordx4 v[48:51], v248, s[12:15], s40 offen offset:1024 sc1
    s_mov_b64 exec, -1
    s_waitcnt lgkmcnt(0)
    buffer_store_dwordx4 v[52:55], v247, s[12:15], s42 offen sc1
    buffer_store_dwordx4 v[56:59], v247, s[12:15], s43 offen sc1
    s_mov_b64 exec, 0xffffffff
    buffer_store_dwordx4 v[60:63], v248, s[12:15], s42 offen offset:1024 sc1
    s_mov_b64 exec, 1
    s_waitcnt vmcnt(0)
    buffer_store_dwordx2 v[18:19], v14, s[12:15], s44 offen sc1
    s_mov_b64 exec, -1
L_A_phase2:
    v_and_b32 v1, 63, v0
    v_and_b32_e64 v16, 15, v1
    v_lshrrev_b32 v17, 4, v1
    s_lshr_b32 s77, s3, 2
    s_lshr_b32 s21, s30, 2
    s_and_b32 s31, s29, 3
    s_lshl_b32 s31, s31, 2
    s_and_b32 s69, s30, 3
    s_add_u32 s20, s31, s69
    s_lshl_b32 s31, s20, 3
    s_lshl_b32 s69, s67, 1
    s_add_u32 s31, s31, s69
    s_mul_i32 s31, s31, 20480
    s_mul_i32 s69, s77, 10240
    s_add_u32 s31, s31, s69
    s_add_u32 s42, s31, 1048576
    s_add_u32 s43, s42, 4096
    s_add_u32 s44, s42, 8192
    v_lshlrev_b32 v5, 4, v1
    v_add_u32 v6, 20480, v5
    v_lshrrev_b32 v4, 1, v17
    v_and_b32 v3, 1, v17
    v_lshlrev_b32_e64 v4, 4, v4
    v_lshl_add_u32 v4, v3, 2, v4
    v_bfe_u32 v3, v1, 2, 2
    v_add_u32_e64 v4, v4, v3
    v_mul_u32_u24 v4, 160, v4
    v_and_b32_e64 v3, 3, v1
    v_lshl_add_u32 v4, v3, 3, v4
    s_mul_i32 s31, s77, 51200
    v_add_u32_e64 v8, s31, v4
    s_mov_b32 s16, s58
    s_mov_b32 s17, s59
    s_mov_b32 s18, 10485760
    s_mov_b32 s69, 3277
    s_mul_i32 s31, s67, 21504
    s_mul_i32 s68, s77, 5376
    s_add_u32 s31, s31, s68
    s_add_u32 s31, s31, 0
    v_add_u32_e64 v2, 0, v1
    v_mul_u32_u24 v3, 3277, v2
    v_lshrrev_b32 v3, 16, v3
    v_mul_u32_u24 v4, 20, v3
    v_sub_u32_e64 v2, v2, v4
    v_mul_u32_u24 v4, 336, v3
    v_lshl_add_u32 v4, v2, 4, v4
    v_add_u32_e64 v180, s31, v4
    v_mul_u32_u24 v4, 5120, v3
    v_lshl_add_u32 v185, v2, 4, v4
    v_add_u32_e64 v2, 64, v1
    v_mul_u32_u24 v3, 3277, v2
    v_lshrrev_b32 v3, 16, v3
    v_mul_u32_u24 v4, 20, v3
    v_sub_u32_e64 v2, v2, v4
    v_mul_u32_u24 v4, 336, v3
    v_lshl_add_u32 v4, v2, 4, v4
    v_add_u32_e64 v181, s31, v4
    v_mul_u32_u24 v4, 5120, v3
    v_lshl_add_u32 v186, v2, 4, v4
    v_add_u32 v2, 128, v1
    v_mul_u32_u24 v3, 3277, v2
    v_lshrrev_b32 v3, 16, v3
    v_mul_u32_u24 v4, 20, v3
    v_sub_u32_e64 v2, v2, v4
    v_mul_u32_u24 v4, 336, v3
    v_lshl_add_u32 v4, v2, 4, v4
    v_add_u32_e64 v182, s31, v4
    v_mul_u32_u24 v4, 5120, v3
    v_lshl_add_u32 v187, v2, 4, v4
    v_add_u32 v2, 192, v1
    v_mul_u32_u24 v3, 3277, v2
    v_lshrrev_b32 v3, 16, v3
    v_mul_u32_u24 v4, 20, v3
    v_sub_u32_e64 v2, v2, v4
    v_mul_u32_u24 v4, 336, v3
    v_lshl_add_u32 v4, v2, 4, v4
    v_add_u32_e64 v183, s31, v4
    v_mul_u32_u24 v4, 5120, v3
    v_lshl_add_u32 v188, v2, 4, v4
    v_add_u32 v2, 256, v1
    v_mul_u32_u24 v3, 3277, v2
    v_lshrrev_b32 v3, 16, v3
    v_mul_u32_u24 v4, 20, v3
    v_sub_u32_e64 v2, v2, v4
    v_mul_u32_u24 v4, 336, v3
    v_lshl_add_u32 v4, v2, 4, v4
    v_add_u32_e64 v184, s31, v4
    v_mul_u32_u24 v4, 5120, v3
    v_lshl_add_u32 v189, v2, 4, v4
    s_mul_i32 s31, s67, 21504
    s_mul_i32 s68, s77, 10752
    s_add_u32 s31, s31, s68
    s_add_u32 s31, s31, 0
    v_mul_u32_u24 v7, 336, v16
    v_lshl_add_u32 v7, v17, 4, v7
    v_add_u32 v7, s31, v7
    s_lshl_b32 s26, s20, 7
    s_lshl_b32 s31, s67, 5
    s_add_u32 s26, s26, s31
    s_lshl_b32 s31, s77, 4
    s_add_u32 s27, s26, s31
    s_mul_i32 s26, s27, 5120
    s_mul_i32 s31, s21, 320
    s_add_u32 s26, s26, s31
    s_add_u32 s26, s26, 0
    s_cmp_eq_u32 s3, 0
    s_cbranch_scc0 L_rdy0_ok
    s_lshl_b32 s31, s20, 8
    s_add_u32 s31, s31, 4096
    v_and_b32 v2, 31, v1
    v_lshlrev_b32 v2, 3, v2
    s_mov_b32 s79, 0
L_rdy0:
    buffer_load_dwordx2 v[248:249], v2, s[12:15], s31 offen sc1
    s_waitcnt vmcnt(0)
    v_cmp_ne_u64 vcc, s[72:73], v[248:249]
    s_cbranch_vccz L_rdy0_ok
    s_sleep 2
    s_add_u32 s79, s79, 1
    s_cmp_lt_u32 s79, 0x8000
    s_cbranch_scc1 L_rdy0
L_rdy0_ok:
    s_waitcnt vmcnt(0)
    s_cmp_eq_u32 s3, 5
    s_cbranch_scc0 L_eb_20
    v_readfirstlane_b32 s31, v105
    s_nop 3
    s_cmp_eq_u32 s31, 255
    s_cbranch_scc0 L_eb_20
    v_mov_b32 v250, s72
    v_mov_b32 v251, s73
    v_mov_b32 v249, 0
    s_mov_b64 exec, 1
    global_store_dwordx2 v249, v[250:251], s[62:63] sc1
    s_mov_b64 exec, -1
    s_waitcnt vmcnt(0)
L_eb_20:
    s_barrier
    buffer_load_dwordx4 v[60:63], v5, s[12:15], s42 offen offset:0
    buffer_load_dwordx4 v[64:67], v6, s[12:15], s42 offen offset:0
    buffer_load_dwordx4 v[68:71], v5, s[12:15], s42 offen offset:1024
    buffer_load_dwordx4 v[72:75], v6, s[12:15], s42 offen offset:1024
    buffer_load_dwordx4 v[76:79], v5, s[12:15], s42 offen offset:2048
    buffer_load_dwordx4 v[80:83], v6, s[12:15], s42 offen offset:2048
    buffer_load_dwordx4 v[84:87], v5, s[12:15], s42 offen offset:3072
    buffer_load_dwordx4 v[88:91], v6, s[12:15], s42 offen offset:3072
    ds_read_b64_tr_b16 v[140:141], v8 offset:0
    ds_read_b64_tr_b16 v[142:143], v8 offset:1280
    ds_read_b64_tr_b16 v[144:145], v8 offset:32
    ds_read_b64_tr_b16 v[146:147], v8 offset:1312
    ds_read_b64_tr_b16 v[148:149], v8 offset:64
    ds_read_b64_tr_b16 v[150:151], v8 offset:1344
    ds_read_b64_tr_b16 v[152:153], v8 offset:96
    ds_read_b64_tr_b16 v[154:155], v8 offset:1376
    ds_read_b64_tr_b16 v[156:157], v8 offset:128
    ds_read_b64_tr_b16 v[158:159], v8 offset:1408
    s_waitcnt vmcnt(6)
    s_waitcnt lgkmcnt(8)
    s_nop 0
    v_mfma_f32_16x16x32_bf16 v[20:23], v[140:143], v[60:63], 0
    ds_read_b64_tr_b16 v[160:161], v8 offset:5120
    v_mfma_f32_16x16x32_bf16 v[40:43], v[140:143], v[64:67], 0
    ds_read_b64_tr_b16 v[162:163], v8 offset:6400
    buffer_load_dwordx4 v[92:95], v5, s[12:15], s43 offen offset:0
    s_waitcnt lgkmcnt(8)
    s_nop 0
    v_mfma_f32_16x16x32_bf16 v[24:27], v[144:147], v[60:63], 0
    ds_read_b64_tr_b16 v[164:165], v8 offset:5152
    v_mfma_f32_16x16x32_bf16 v[44:47], v[144:147], v[64:67], 0
    ds_read_b64_tr_b16 v[166:167], v8 offset:6432
    s_waitcnt lgkmcnt(8)
    s_nop 0
    v_mfma_f32_16x16x32_bf16 v[28:31], v[148:151], v[60:63], 0
    ds_read_b64_tr_b16 v[168:169], v8 offset:5184
    v_mfma_f32_16x16x32_bf16 v[48:51], v[148:151], v[64:67], 0
    ds_read_b64_tr_b16 v[170:171], v8 offset:6464
    buffer_load_dwordx4 v[96:99], v6, s[12:15], s43 offen offset:0
    s_waitcnt lgkmcnt(8)
    s_nop 0
    v_mfma_f32_16x16x32_bf16 v[32:35], v[152:155], v[60:63], 0
    ds_read_b64_tr_b16 v[172:173], v8 offset:5216
    v_mfma_f32_16x16x32_bf16 v[52:55], v[152:155], v[64:67], 0
    ds_read_b64_tr_b16 v[174:175], v8 offset:6496
    s_waitcnt lgkmcnt(8)
    s_nop 0
    v_mfma_f32_16x16x32_bf16 v[36:39], v[156:159], v[60:63], 0
    ds_read_b64_tr_b16 v[176:177], v8 offset:5248
    v_mfma_f32_16x16x32_bf16 v[56:59], v[156:159], v[64:67], 0
    ds_read_b64_tr_b16 v[178:179], v8 offset:6528
    s_waitcnt vmcnt(6)
    s_waitcnt lgkmcnt(8)
    v_mfma_f32_16x16x32_bf16 v[20:23], v[160:163], v[68:71], v[20:23]
    ds_read_b64_tr_b16 v[140:141], v8 offset:10240
    v_mfma_f32_16x16x32_bf16 v[40:43], v[160:163], v[72:75], v[40:43]
    ds_read_b64_tr_b16 v[142:143], v8 offset:11520
    buffer_load_dwordx4 v[100:103], v5, s[12:15], s43 offen offset:1024
    s_waitcnt lgkmcnt(8)
    s_nop 0
    v_mfma_f32_16x16x32_bf16 v[24:27], v[164:167], v[68:71], v[24:27]
    ds_read_b64_tr_b16 v[144:145], v8 offset:10272
    v_mfma_f32_16x16x32_bf16 v[44:47], v[164:167], v[72:75], v[44:47]
    ds_read_b64_tr_b16 v[146:147], v8 offset:11552
    s_waitcnt lgkmcnt(8)
    s_nop 0
    v_mfma_f32_16x16x32_bf16 v[28:31], v[168:171], v[68:71], v[28:31]
    ds_read_b64_tr_b16 v[148:149], v8 offset:10304
    v_mfma_f32_16x16x32_bf16 v[48:51], v[168:171], v[72:75], v[48:51]
    ds_read_b64_tr_b16 v[150:151], v8 offset:11584
    buffer_load_dwordx4 v[104:107], v6, s[12:15], s43 offen offset:1024
    s_waitcnt lgkmcnt(8)
    s_nop 0
    v_mfma_f32_16x16x32_bf16 v[32:35], v[172:175], v[68:71], v[32:35]
    ds_read_b64_tr_b16 v[152:153], v8 offset:10336
    v_mfma_f32_16x16x32_bf16 v[52:55], v[172:175], v[72:75], v[52:55]
    ds_read_b64_tr_b16 v[154:155], v8 offset:11616
    s_waitcnt lgkmcnt(8)
    s_nop 0
    v_mfma_f32_16x16x32_bf16 v[36:39], v[176:179], v[68:71], v[36:39]
    ds_read_b64_tr_b16 v[156:157], v8 offset:10368
    v_mfma_f32_16x16x32_bf16 v[56:59], v[176:179], v[72:75], v[56:59]
    ds_read_b64_tr_b16 v[158:159], v8 offset:11648
    s_waitcnt vmcnt(6)
    s_waitcnt lgkmcnt(8)
    v_mfma_f32_16x16x32_bf16 v[20:23], v[140:143], v[76:79], v[20:23]
    ds_read_b64_tr_b16 v[160:161], v8 offset:15360
    v_mfma_f32_16x16x32_bf16 v[40:43], v[140:143], v[80:83], v[40:43]
    ds_read_b64_tr_b16 v[162:163], v8 offset:16640
    buffer_load_dwordx4 v[108:111], v5, s[12:15], s43 offen offset:2048
    s_waitcnt lgkmcnt(8)
    s_nop 0
    v_mfma_f32_16x16x32_bf16 v[24:27], v[144:147], v[76:79], v[24:27]
    ds_read_b64_tr_b16 v[164:165], v8 offset:15392
    v_mfma_f32_16x16x32_bf16 v[44:47], v[144:147], v[80:83], v[44:47]
    ds_read_b64_tr_b16 v[166:167], v8 offset:16672
    s_waitcnt lgkmcnt(8)
    s_nop 0
    v_mfma_f32_16x16x32_bf16 v[28:31], v[148:151], v[76:79], v[28:31]
    ds_read_b64_tr_b16 v[168:169], v8 offset:15424
    v_mfma_f32_16x16x32_bf16 v[48:51], v[148:151], v[80:83], v[48:51]
    ds_read_b64_tr_b16 v[170:171], v8 offset:16704
    buffer_load_dwordx4 v[112:115], v6, s[12:15], s43 offen offset:2048
    s_waitcnt lgkmcnt(8)
    s_nop 0
    v_mfma_f32_16x16x32_bf16 v[32:35], v[152:155], v[76:79], v[32:35]
    ds_read_b64_tr_b16 v[172:173], v8 offset:15456
    v_mfma_f32_16x16x32_bf16 v[52:55], v[152:155], v[80:83], v[52:55]
    ds_read_b64_tr_b16 v[174:175], v8 offset:16736
    s_waitcnt lgkmcnt(8)
    s_nop 0
    v_mfma_f32_16x16x32_bf16 v[36:39], v[156:159], v[76:79], v[36:39]
    ds_read_b64_tr_b16 v[176:177], v8 offset:15488
    v_mfma_f32_16x16x32_bf16 v[56:59], v[156:159], v[80:83], v[56:59]
    ds_read_b64_tr_b16 v[178:179], v8 offset:16768
    s_waitcnt vmcnt(6)
    s_waitcnt lgkmcnt(8)
    v_mfma_f32_16x16x32_bf16 v[20:23], v[160:163], v[84:87], v[20:23]
    ds_read_b64_tr_b16 v[140:141], v8 offset:20480
    v_mfma_f32_16x16x32_bf16 v[40:43], v[160:163], v[88:91], v[40:43]
    ds_read_b64_tr_b16 v[142:143], v8 offset:21760
    buffer_load_dwordx4 v[116:119], v5, s[12:15], s43 offen offset:3072
    s_waitcnt lgkmcnt(8)
    s_nop 0
    v_mfma_f32_16x16x32_bf16 v[24:27], v[164:167], v[84:87], v[24:27]
    ds_read_b64_tr_b16 v[144:145], v8 offset:20512
    v_mfma_f32_16x16x32_bf16 v[44:47], v[164:167], v[88:91], v[44:47]
    ds_read_b64_tr_b16 v[146:147], v8 offset:21792
    s_waitcnt lgkmcnt(8)
    s_nop 0
    v_mfma_f32_16x16x32_bf16 v[28:31], v[168:171], v[84:87], v[28:31]
    ds_read_b64_tr_b16 v[148:149], v8 offset:20544
    v_mfma_f32_16x16x32_bf16 v[48:51], v[168:171], v[88:91], v[48:51]
    ds_read_b64_tr_b16 v[150:151], v8 offset:21824
    buffer_load_dwordx4 v[120:123], v6, s[12:15], s43 offen offset:3072
    s_waitcnt lgkmcnt(8)
    s_nop 0
    v_mfma_f32_16x16x32_bf16 v[32:35], v[172:175], v[84:87], v[32:35]
    ds_read_b64_tr_b16 v[152:153], v8 offset:20576
    v_mfma_f32_16x16x32_bf16 v[52:55], v[172:175], v[88:91], v[52:55]
    ds_read_b64_tr_b16 v[154:155], v8 offset:21856
    s_waitcnt lgkmcnt(8)
    s_nop 0
    v_mfma_f32_16x16x32_bf16 v[36:39], v[176:179], v[84:87], v[36:39]
    ds_read_b64_tr_b16 v[156:157], v8 offset:20608
    v_mfma_f32_16x16x32_bf16 v[56:59], v[176:179], v[88:91], v[56:59]
    ds_read_b64_tr_b16 v[158:159], v8 offset:21888
    s_waitcnt vmcnt(6)
    s_waitcnt lgkmcnt(8)
    v_mfma_f32_16x16x32_bf16 v[20:23], v[140:143], v[92:95], v[20:23]
    ds_read_b64_tr_b16 v[160:161], v8 offset:25600
    v_mfma_f32_16x16x32_bf16 v[40:43], v[140:143], v[96:99], v[40:43]
    ds_read_b64_tr_b16 v[162:163], v8 offset:26880
    buffer_load_dwordx4 v[124:127], v5, s[12:15], s44 offen offset:0
    s_waitcnt lgkmcnt(8)
    s_nop 0
    v_mfma_f32_16x16x32_bf16 v[24:27], v[144:147], v[92:95], v[24:27]
    ds_read_b64_tr_b16 v[164:165], v8 offset:25632
    v_mfma_f32_16x16x32_bf16 v[44:47], v[144:147], v[96:99], v[44:47]
    ds_read_b64_tr_b16 v[166:167], v8 offset:26912
    s_waitcnt lgkmcnt(8)
    s_nop 0
    v_mfma_f32_16x16x32_bf16 v[28:31], v[148:151], v[92:95], v[28:31]
    ds_read_b64_tr_b16 v[168:169], v8 offset:25664
    v_mfma_f32_16x16x32_bf16 v[48:51], v[148:151], v[96:99], v[48:51]
    ds_read_b64_tr_b16 v[170:171], v8 offset:26944
    buffer_load_dwordx4 v[128:131], v6, s[12:15], s44 offen offset:0
    s_waitcnt lgkmcnt(8)
    s_nop 0
    v_mfma_f32_16x16x32_bf16 v[32:35], v[152:155], v[92:95], v[32:35]
    ds_read_b64_tr_b16 v[172:173], v8 offset:25696
    v_mfma_f32_16x16x32_bf16 v[52:55], v[152:155], v[96:99], v[52:55]
    ds_read_b64_tr_b16 v[174:175], v8 offset:26976
    s_waitcnt lgkmcnt(8)
    s_nop 0
    v_mfma_f32_16x16x32_bf16 v[36:39], v[156:159], v[92:95], v[36:39]
    ds_read_b64_tr_b16 v[176:177], v8 offset:25728
    v_mfma_f32_16x16x32_bf16 v[56:59], v[156:159], v[96:99], v[56:59]
    ds_read_b64_tr_b16 v[178:179], v8 offset:27008
    s_waitcnt vmcnt(6)
    s_waitcnt lgkmcnt(8)
    v_mfma_f32_16x16x32_bf16 v[20:23], v[160:163], v[100:103], v[20:23]
    ds_read_b64_tr_b16 v[140:141], v8 offset:30720
    v_mfma_f32_16x16x32_bf16 v[40:43], v[160:163], v[104:107], v[40:43]
    ds_read_b64_tr_b16 v[142:143], v8 offset:32000
    buffer_load_dwordx4 v[132:135], v5, s[12:15], s44 offen offset:1024
    s_waitcnt lgkmcnt(8)
    s_nop 0
    v_mfma_f32_16x16x32_bf16 v[24:27], v[164:167], v[100:103], v[24:27]
    ds_read_b64_tr_b16 v[144:145], v8 offset:30752
    v_mfma_f32_16x16x32_bf16 v[44:47], v[164:167], v[104:107], v[44:47]
    ds_read_b64_tr_b16 v[146:147], v8 offset:32032
    s_waitcnt lgkmcnt(8)
    s_nop 0
    v_mfma_f32_16x16x32_bf16 v[28:31], v[168:171], v[100:103], v[28:31]
    ds_read_b64_tr_b16 v[148:149], v8 offset:30784
    v_mfma_f32_16x16x32_bf16 v[48:51], v[168:171], v[104:107], v[48:51]
    ds_read_b64_tr_b16 v[150:151], v8 offset:32064
    buffer_load_dwordx4 v[136:139], v6, s[12:15], s44 offen offset:1024
    s_waitcnt lgkmcnt(8)
    s_nop 0
    v_mfma_f32_16x16x32_bf16 v[32:35], v[172:175], v[100:103], v[32:35]
    ds_read_b64_tr_b16 v[152:153], v8 offset:30816
    v_mfma_f32_16x16x32_bf16 v[52:55], v[172:175], v[104:107], v[52:55]
    ds_read_b64_tr_b16 v[154:155], v8 offset:32096
    s_waitcnt lgkmcnt(8)
    s_nop 0
    v_mfma_f32_16x16x32_bf16 v[36:39], v[176:179], v[100:103], v[36:39]
    ds_read_b64_tr_b16 v[156:157], v8 offset:30848
    v_mfma_f32_16x16x32_bf16 v[56:59], v[176:179], v[104:107], v[56:59]
    ds_read_b64_tr_b16 v[158:159], v8 offset:32128
    s_waitcnt vmcnt(6)
    s_waitcnt lgkmcnt(8)
    v_mfma_f32_16x16x32_bf16 v[20:23], v[140:143], v[108:111], v[20:23]
    ds_read_b64_tr_b16 v[160:161], v8 offset:35840
    v_mfma_f32_16x16x32_bf16 v[40:43], v[140:143], v[112:115], v[40:43]
    ds_read_b64_tr_b16 v[162:163], v8 offset:37120
    s_waitcnt lgkmcnt(8)
    s_nop 0
    v_mfma_f32_16x16x32_bf16 v[24:27], v[144:147], v[108:111], v[24:27]
    ds_read_b64_tr_b16 v[164:165], v8 offset:35872
    v_mfma_f32_16x16x32_bf16 v[44:47], v[144:147], v[112:115], v[44:47]
    ds_read_b64_tr_b16 v[166:167], v8 offset:37152
    s_waitcnt lgkmcnt(8)
    s_nop 0
    v_mfma_f32_16x16x32_bf16 v[28:31], v[148:151], v[108:111], v[28:31]
    ds_read_b64_tr_b16 v[168:169], v8 offset:35904
    v_mfma_f32_16x16x32_bf16 v[48:51], v[148:151], v[112:115], v[48:51]
    ds_read_b64_tr_b16 v[170:171], v8 offset:37184
    s_waitcnt lgkmcnt(8)
    s_nop 0
    v_mfma_f32_16x16x32_bf16 v[32:35], v[152:155], v[108:111], v[32:35]
    ds_read_b64_tr_b16 v[172:173], v8 offset:35936
    v_mfma_f32_16x16x32_bf16 v[52:55], v[152:155], v[112:115], v[52:55]
    ds_read_b64_tr_b16 v[174:175], v8 offset:37216
    s_waitcnt lgkmcnt(8)
    s_nop 0
    v_mfma_f32_16x16x32_bf16 v[36:39], v[156:159], v[108:111], v[36:39]
    ds_read_b64_tr_b16 v[176:177], v8 offset:35968
    v_mfma_f32_16x16x32_bf16 v[56:59], v[156:159], v[112:115], v[56:59]
    ds_read_b64_tr_b16 v[178:179], v8 offset:37248
    s_waitcnt vmcnt(4)
    s_waitcnt lgkmcnt(8)
    v_mfma_f32_16x16x32_bf16 v[20:23], v[160:163], v[116:119], v[20:23]
    ds_read_b64_tr_b16 v[140:141], v8 offset:40960
    v_mfma_f32_16x16x32_bf16 v[40:43], v[160:163], v[120:123], v[40:43]
    ds_read_b64_tr_b16 v[142:143], v8 offset:42240
    s_waitcnt lgkmcnt(8)
    s_nop 0
    v_mfma_f32_16x16x32_bf16 v[24:27], v[164:167], v[116:119], v[24:27]
    ds_read_b64_tr_b16 v[144:145], v8 offset:40992
    v_mfma_f32_16x16x32_bf16 v[44:47], v[164:167], v[120:123], v[44:47]
    ds_read_b64_tr_b16 v[146:147], v8 offset:42272
    s_waitcnt lgkmcnt(8)
    s_nop 0
    v_mfma_f32_16x16x32_bf16 v[28:31], v[168:171], v[116:119], v[28:31]
    ds_read_b64_tr_b16 v[148:149], v8 offset:41024
    v_mfma_f32_16x16x32_bf16 v[48:51], v[168:171], v[120:123], v[48:51]
    ds_read_b64_tr_b16 v[150:151], v8 offset:42304
    s_waitcnt lgkmcnt(8)
    s_nop 0
    v_mfma_f32_16x16x32_bf16 v[32:35], v[172:175], v[116:119], v[32:35]
    ds_read_b64_tr_b16 v[152:153], v8 offset:41056
    v_mfma_f32_16x16x32_bf16 v[52:55], v[172:175], v[120:123], v[52:55]
    ds_read_b64_tr_b16 v[154:155], v8 offset:42336
    s_waitcnt lgkmcnt(8)
    s_nop 0
    v_mfma_f32_16x16x32_bf16 v[36:39], v[176:179], v[116:119], v[36:39]
    ds_read_b64_tr_b16 v[156:157], v8 offset:41088
    v_mfma_f32_16x16x32_bf16 v[56:59], v[176:179], v[120:123], v[56:59]
    ds_read_b64_tr_b16 v[158:159], v8 offset:42368
    s_waitcnt vmcnt(2)
    s_waitcnt lgkmcnt(8)
    v_mfma_f32_16x16x32_bf16 v[20:23], v[140:143], v[124:127], v[20:23]
    ds_read_b64_tr_b16 v[160:161], v8 offset:46080
    v_mfma_f32_16x16x32_bf16 v[40:43], v[140:143], v[128:131], v[40:43]
    ds_read_b64_tr_b16 v[162:163], v8 offset:47360
    s_waitcnt lgkmcnt(8)
    s_nop 0
    v_mfma_f32_16x16x32_bf16 v[24:27], v[144:147], v[124:127], v[24:27]
    ds_read_b64_tr_b16 v[164:165], v8 offset:46112
    v_mfma_f32_16x16x32_bf16 v[44:47], v[144:147], v[128:131], v[44:47]
    ds_read_b64_tr_b16 v[166:167], v8 offset:47392
    s_waitcnt lgkmcnt(8)
    s_nop 0
    v_mfma_f32_16x16x32_bf16 v[28:31], v[148:151], v[124:127], v[28:31]
    ds_read_b64_tr_b16 v[168:169], v8 offset:46144
    v_mfma_f32_16x16x32_bf16 v[48:51], v[148:151], v[128:131], v[48:51]
    ds_read_b64_tr_b16 v[170:171], v8 offset:47424
    s_waitcnt lgkmcnt(8)
    s_nop 0
    v_mfma_f32_16x16x32_bf16 v[32:35], v[152:155], v[124:127], v[32:35]
    ds_read_b64_tr_b16 v[172:173], v8 offset:46176
    v_mfma_f32_16x16x32_bf16 v[52:55], v[152:155], v[128:131], v[52:55]
    ds_read_b64_tr_b16 v[174:175], v8 offset:47456
    s_waitcnt lgkmcnt(8)
    s_nop 0
    v_mfma_f32_16x16x32_bf16 v[36:39], v[156:159], v[124:127], v[36:39]
    ds_read_b64_tr_b16 v[176:177], v8 offset:46208
    v_mfma_f32_16x16x32_bf16 v[56:59], v[156:159], v[128:131], v[56:59]
    ds_read_b64_tr_b16 v[178:179], v8 offset:47488
    s_waitcnt vmcnt(0)
    s_waitcnt lgkmcnt(8)
    v_mfma_f32_16x16x32_bf16 v[20:23], v[160:163], v[132:135], v[20:23]
    v_mfma_f32_16x16x32_bf16 v[40:43], v[160:163], v[136:139], v[40:43]
    s_waitcnt lgkmcnt(6)
    s_nop 0
    v_mfma_f32_16x16x32_bf16 v[24:27], v[164:167], v[132:135], v[24:27]
    v_mfma_f32_16x16x32_bf16 v[44:47], v[164:167], v[136:139], v[44:47]
    s_waitcnt lgkmcnt(4)
    s_nop 0
    v_mfma_f32_16x16x32_bf16 v[28:31], v[168:171], v[132:135], v[28:31]
    v_mfma_f32_16x16x32_bf16 v[48:51], v[168:171], v[136:139], v[48:51]
    s_waitcnt lgkmcnt(2)
    s_nop 0
    v_mfma_f32_16x16x32_bf16 v[32:35], v[172:175], v[132:135], v[32:35]
    v_mfma_f32_16x16x32_bf16 v[52:55], v[172:175], v[136:139], v[52:55]
    s_waitcnt lgkmcnt(0)
    s_nop 0
    v_mfma_f32_16x16x32_bf16 v[36:39], v[176:179], v[132:135], v[36:39]
    v_mfma_f32_16x16x32_bf16 v[56:59], v[176:179], v[136:139], v[56:59]
    s_nop 4
    s_barrier
    ds_write_b128 v7, v[20:23] offset:0
    ds_write_b128 v7, v[24:27] offset:64
    ds_write_b128 v7, v[28:31] offset:128
    ds_write_b128 v7, v[32:35] offset:192
    ds_write_b128 v7, v[36:39] offset:256
    ds_write_b128 v7, v[40:43] offset:5376
    ds_write_b128 v7, v[44:47] offset:5440
    ds_write_b128 v7, v[48:51] offset:5504
    ds_write_b128 v7, v[52:55] offset:5568
    ds_write_b128 v7, v[56:59] offset:5632
    s_waitcnt lgkmcnt(0)
    s_barrier
    ds_read_b128 v[60:63], v180
    ds_read_b128 v[64:67], v180 offset:10752
    ds_read_b128 v[68:71], v181
    ds_read_b128 v[72:75], v181 offset:10752
    ds_read_b128 v[76:79], v182
    ds_read_b128 v[80:83], v182 offset:10752
    ds_read_b128 v[84:87], v183
    ds_read_b128 v[88:91], v183 offset:10752
    ds_read_b128 v[92:95], v184
    ds_read_b128 v[96:99], v184 offset:10752
    s_waitcnt lgkmcnt(8)
    v_add_f32 v60, v60, v64
    v_add_f32 v61, v61, v65
    v_add_f32 v62, v62, v66
    v_add_f32_e64 v63, v63, v67
    buffer_store_dwordx4 v[60:63], v185, s[16:19], s26 offen sc1
    s_waitcnt lgkmcnt(6)
    v_add_f32 v68, v68, v72
    v_add_f32 v69, v69, v73
    v_add_f32 v70, v70, v74
    v_add_f32_e64 v71, v71, v75
    buffer_store_dwordx4 v[68:71], v186, s[16:19], s26 offen sc1
    s_waitcnt lgkmcnt(4)
    v_add_f32 v76, v76, v80
    v_add_f32 v77, v77, v81
    v_add_f32 v78, v78, v82
    v_add_f32_e64 v79, v79, v83
    buffer_store_dwordx4 v[76:79], v187, s[16:19], s26 offen sc1
    s_waitcnt lgkmcnt(2)
    v_add_f32 v84, v84, v88
    v_add_f32 v85, v85, v89
    v_add_f32 v86, v86, v90
    v_add_f32_e64 v87, v87, v91
    buffer_store_dwordx4 v[84:87], v188, s[16:19], s26 offen sc1
    s_waitcnt lgkmcnt(0)
    v_add_f32 v92, v92, v96
    v_add_f32 v93, v93, v97
    v_add_f32 v94, v94, v98
    v_add_f32_e64 v95, v95, v99
    buffer_store_dwordx4 v[92:95], v189, s[16:19], s26 offen sc1
    s_branch L_fin
L_B:
    v_lshrrev_b32 v18, 2, v16
    v_and_b32_e64 v19, 1, v16
    v_lshl_add_u32 v2, v18, 1, v19
    v_lshlrev_b32_e64 v3, 3, v2
    v_bfe_u32 v4, v16, 1, 1
    v_add_u32 v3, v3, v4
    v_lshlrev_b32 v3, 7, v3
    s_lshl_b32 s31, s3, 13
    v_add_u32 v3, s31, v3
    v_xor_b32_e64 v2, v2, v17
    v_lshl_add_u32 v8, v2, 4, v3
    v_xor_b32_e64 v2, 4, v2
    v_lshl_add_u32 v9, v2, 4, v3
    v_lshrrev_b32 v2, 1, v16
    v_xor_b32 v2, v2, v17
    v_lshlrev_b32_e64 v3, 7, v16
    v_add_u32 v3, 32768, v3
    v_lshl_add_u32 v10, v2, 4, v3
    v_xor_b32_e64 v2, 4, v2
    v_lshl_add_u32 v11, v2, 4, v3
    v_and_b32 v4, 8, v16
    v_lshlrev_b32 v4, 9, v4
    v_add_u32 v4, 4096, v4
    v_add_u32 v12, v10, v4
    v_add_u32 v13, v11, v4
    s_mul_i32 s31, s21, 40
    v_add_u32 v2, s31, v16
    v_lshlrev_b32 v2, 1, v2
    v_and_b32 v3, 7, v16
    v_add_u32 v3, s31, v3
    v_lshlrev_b32 v3, 1, v3
    global_load_ushort v228, v2, s[42:43] offset:0
    global_load_ushort v229, v2, s[44:45] offset:0
    global_load_ushort v230, v2, s[54:55] offset:0
    global_load_ushort v231, v2, s[42:43] offset:32
    global_load_ushort v232, v2, s[44:45] offset:32
    global_load_ushort v233, v2, s[54:55] offset:32
    global_load_ushort v234, v3, s[42:43] offset:64
    global_load_ushort v235, v3, s[44:45] offset:64
    global_load_ushort v236, v3, s[54:55] offset:64
    v_mov_b64 v[84:85], 0
    v_mov_b64 v[86:87], 0
    v_mov_b64 v[88:89], 0
    v_mov_b64 v[90:91], 0
    v_mov_b64 v[92:93], 0
    v_mov_b64 v[94:95], 0
    v_mov_b64 v[96:97], 0
    v_mov_b64 v[98:99], 0
    v_mov_b64 v[100:101], 0
    v_mov_b64 v[102:103], 0
    v_mov_b64 v[116:117], 0
    v_mov_b64 v[118:119], 0
    v_mov_b64 v[120:121], 0
    v_mov_b64 v[122:123], 0
    v_mov_b64 v[124:125], 0
    v_mov_b64 v[126:127], 0
    v_mov_b64 v[128:129], 0
    v_mov_b64 v[130:131], 0
    v_mov_b64 v[132:133], 0
    v_mov_b64 v[134:135], 0
    v_mov_b64 v[148:149], 0
    v_mov_b64 v[150:151], 0
    v_mov_b64 v[152:153], 0
    v_mov_b64 v[154:155], 0
    v_mov_b64 v[156:157], 0
    v_mov_b64 v[158:159], 0
    v_mov_b64 v[160:161], 0
    v_mov_b64 v[162:163], 0
    v_mov_b64 v[164:165], 0
    v_mov_b64 v[166:167], 0
    v_mov_b64 v[180:181], 0
    v_mov_b64 v[182:183], 0
    v_mov_b64 v[184:185], 0
    v_mov_b64 v[186:187], 0
    v_mov_b64 v[188:189], 0
    v_mov_b64 v[190:191], 0
    v_mov_b64 v[192:193], 0
    v_mov_b64 v[194:195], 0
    v_mov_b64 v[196:197], 0
    v_mov_b64 v[198:199], 0
    s_mov_b32 s78, 1069066811
    s_mov_b32 s79, 0x3e22f983
    v_lshlrev_b32 v4, 4, v17
    v_cvt_f32_u32 v5, v4
    s_lshl_b32 s31, s3, 6
    v_add_u32 v4, s31, v4
    v_cvt_f32_u32 v6, v4
    v_and_b32 v7, 8, v16
    v_lshlrev_b32 v7, 28, v7
    s_waitcnt vmcnt(0)
    v_lshlrev_b32 v228, 16, v228
    v_lshlrev_b32 v229, 16, v229
    v_lshlrev_b32 v230, 16, v230
    v_mul_f32_e64 v230, s78, v230
    v_exp_f32 v230, v230
    s_nop 0
    v_cvt_pk_bf16_f32 v230, v230, v230
    v_and_b32 v230, 0xffff0000, v230
    v_mul_f32 v14, v230, v228
    v_mul_f32 v15, v230, v229
    v_mul_f32 v14, s78, v14
    v_mul_f32 v15, s79, v15
    v_mul_f32 v18, 1.0, v14
    v_mul_f32 v19, 1.0, v15
    v_exp_f32 v18, v18
    v_fract_f32 v19, v19
    s_nop 0
    v_cos_f32 v108, v19
    v_sin_f32 v109, v19
    s_nop 0
    v_mul_f32 v108, v108, v18
    v_mul_f32 v109, v109, v18
    v_mul_f32 v18, 0x41000000, v14
    v_mul_f32 v19, 0x41000000, v15
    v_exp_f32 v18, v18
    v_fract_f32 v19, v19
    s_nop 0
    v_cos_f32 v112, v19
    v_sin_f32 v113, v19
    s_nop 0
    v_mul_f32 v112, v112, v18
    v_mul_f32 v113, v113, v18
    v_mul_f32 v18, 0x41800000, v14
    v_mul_f32 v19, 0x41800000, v15
    v_exp_f32 v18, v18
    v_fract_f32 v19, v19
    s_nop 0
    v_cos_f32 v114, v19
    v_sin_f32 v115, v19
    s_nop 0
    v_mul_f32 v114, v114, v18
    v_mul_f32 v115, v115, v18
    v_mul_f32 v18, 0x42800000, v14
    v_mul_f32 v19, 0x42800000, v15
    v_exp_f32 v18, v18
    v_fract_f32 v19, v19
    s_nop 0
    v_cos_f32 v140, v19
    v_sin_f32 v141, v19
    s_nop 0
    v_mul_f32 v140, v140, v18
    v_mul_f32 v141, v141, v18
    v_mul_f32 v18, 0x43800000, v14
    v_mul_f32 v19, 0x43800000, v15
    v_exp_f32 v18, v18
    v_fract_f32 v19, v19
    s_nop 0
    v_cos_f32 v142, v19
    v_sin_f32 v143, v19
    s_nop 0
    v_mul_f32 v142, v142, v18
    v_mul_f32 v143, v143, v18
    v_mul_f32 v18, v5, v14
    v_mul_f32 v19, v5, v15
    v_exp_f32 v18, v18
    v_fract_f32 v19, v19
    s_nop 0
    v_cos_f32 v144, v19
    v_sin_f32 v145, v19
    s_nop 0
    v_mul_f32 v144, v144, v18
    v_mul_f32 v145, v145, v18
    v_mul_f32 v18, v6, v14
    v_mul_f32 v19, v6, v15
    v_exp_f32 v18, v18
    v_fract_f32 v19, v19
    s_nop 0
    v_cos_f32 v146, v19
    v_sin_f32 v147, v19
    s_nop 0
    v_mul_f32 v146, v146, v18
    v_mul_f32 v147, v147, v18
    v_mul_f32 v18, v228, v228
    v_fmac_f32 v18, v229, v229
    v_rcp_f32 v18, v18
    v_add_f32 v19, -1.0, v108
    v_mul_f32 v110, v19, v228
    v_fmac_f32 v110, v109, v229
    v_mul_f32_e64 v111, v109, v228
    v_fma_f32 v111, -v19, v229, v111
    v_add_f32 v18, v18, v18
    v_mul_f32 v110, v110, v18
    v_mul_f32 v111, v111, v18
    v_lshlrev_b32 v231, 16, v231
    v_lshlrev_b32 v232, 16, v232
    v_lshlrev_b32 v233, 16, v233
    v_mul_f32_e64 v233, s78, v233
    v_exp_f32 v233, v233
    s_nop 0
    v_cvt_pk_bf16_f32 v233, v233, v233
    v_and_b32 v233, 0xffff0000, v233
    v_mul_f32 v14, v233, v231
    v_mul_f32 v15, v233, v232
    v_mul_f32 v14, s78, v14
    v_mul_f32 v15, s79, v15
    v_mul_f32 v18, 1.0, v14
    v_mul_f32 v19, 1.0, v15
    v_exp_f32 v18, v18
    v_fract_f32 v19, v19
    s_nop 0
    v_cos_f32 v172, v19
    v_sin_f32 v173, v19
    s_nop 0
    v_mul_f32 v172, v172, v18
    v_mul_f32 v173, v173, v18
    v_mul_f32 v18, 0x41000000, v14
    v_mul_f32 v19, 0x41000000, v15
    v_exp_f32 v18, v18
    v_fract_f32 v19, v19
    s_nop 0
    v_cos_f32 v176, v19
    v_sin_f32 v177, v19
    s_nop 0
    v_mul_f32 v176, v176, v18
    v_mul_f32 v177, v177, v18
    v_mul_f32 v18, 0x41800000, v14
    v_mul_f32 v19, 0x41800000, v15
    v_exp_f32 v18, v18
    v_fract_f32 v19, v19
    s_nop 0
    v_cos_f32 v178, v19
    v_sin_f32 v179, v19
    s_nop 0
    v_mul_f32 v178, v178, v18
    v_mul_f32 v179, v179, v18
    v_mul_f32 v18, 0x42800000, v14
    v_mul_f32 v19, 0x42800000, v15
    v_exp_f32 v18, v18
    v_fract_f32 v19, v19
    s_nop 0
    v_cos_f32 v204, v19
    v_sin_f32 v205, v19
    s_nop 0
    v_mul_f32 v204, v204, v18
    v_mul_f32 v205, v205, v18
    v_mul_f32 v18, 0x43800000, v14
    v_mul_f32 v19, 0x43800000, v15
    v_exp_f32 v18, v18
    v_fract_f32 v19, v19
    s_nop 0
    v_cos_f32 v206, v19
    v_sin_f32 v207, v19
    s_nop 0
    v_mul_f32 v206, v206, v18
    v_mul_f32 v207, v207, v18
    v_mul_f32 v18, v5, v14
    v_mul_f32 v19, v5, v15
    v_exp_f32 v18, v18
    v_fract_f32 v19, v19
    s_nop 0
    v_cos_f32 v208, v19
    v_sin_f32 v209, v19
    s_nop 0
    v_mul_f32 v208, v208, v18
    v_mul_f32 v209, v209, v18
    v_mul_f32 v18, v6, v14
    v_mul_f32 v19, v6, v15
    v_exp_f32 v18, v18
    v_fract_f32 v19, v19
    s_nop 0
    v_cos_f32 v210, v19
    v_sin_f32 v211, v19
    s_nop 0
    v_mul_f32 v210, v210, v18
    v_mul_f32 v211, v211, v18
    v_mul_f32 v18, v231, v231
    v_fmac_f32 v18, v232, v232
    v_rcp_f32 v18, v18
    v_add_f32 v19, -1.0, v172
    v_mul_f32 v174, v19, v231
    v_fmac_f32 v174, v173, v232
    v_mul_f32_e64 v175, v173, v231
    v_fma_f32 v175, -v19, v232, v175
    v_add_f32 v18, v18, v18
    v_mul_f32 v174, v174, v18
    v_mul_f32 v175, v175, v18
    v_lshlrev_b32 v234, 16, v234
    v_lshlrev_b32 v235, 16, v235
    v_lshlrev_b32 v236, 16, v236
    v_xor_b32 v235, v235, v7
    v_mul_f32 v236, s78, v236
    v_exp_f32 v236, v236
    s_nop 0
    v_cvt_pk_bf16_f32 v236, v236, v236
    v_and_b32 v236, 0xffff0000, v236
    v_mul_f32 v14, v236, v234
    v_mul_f32 v15, v236, v235
    v_mul_f32 v14, s78, v14
    v_mul_f32 v15, s79, v15
    v_mul_f32 v18, 1.0, v14
    v_mul_f32 v19, 1.0, v15
    v_exp_f32 v18, v18
    v_fract_f32 v19, v19
    s_nop 0
    v_cos_f32 v212, v19
    v_sin_f32 v213, v19
    s_nop 0
    v_mul_f32 v212, v212, v18
    v_mul_f32 v213, v213, v18
    v_mul_f32 v18, 0x41000000, v14
    v_mul_f32 v19, 0x41000000, v15
    v_exp_f32 v18, v18
    v_fract_f32 v19, v19
    s_nop 0
    v_cos_f32 v216, v19
    v_sin_f32 v217, v19
    s_nop 0
    v_mul_f32 v216, v216, v18
    v_mul_f32 v217, v217, v18
    v_mul_f32 v18, 0x41800000, v14
    v_mul_f32 v19, 0x41800000, v15
    v_exp_f32 v18, v18
    v_fract_f32 v19, v19
    s_nop 0
    v_cos_f32 v218, v19
    v_sin_f32 v219, v19
    s_nop 0
    v_mul_f32 v218, v218, v18
    v_mul_f32 v219, v219, v18
    v_mul_f32 v18, 0x42800000, v14
    v_mul_f32 v19, 0x42800000, v15
    v_exp_f32 v18, v18
    v_fract_f32 v19, v19
    s_nop 0
    v_cos_f32 v220, v19
    v_sin_f32 v221, v19
    s_nop 0
    v_mul_f32 v220, v220, v18
    v_mul_f32 v221, v221, v18
    v_mul_f32 v18, 0x43800000, v14
    v_mul_f32 v19, 0x43800000, v15
    v_exp_f32 v18, v18
    v_fract_f32 v19, v19
    s_nop 0
    v_cos_f32 v222, v19
    v_sin_f32 v223, v19
    s_nop 0
    v_mul_f32 v222, v222, v18
    v_mul_f32 v223, v223, v18
    v_mul_f32 v18, v5, v14
    v_mul_f32 v19, v5, v15
    v_exp_f32 v18, v18
    v_fract_f32 v19, v19
    s_nop 0
    v_cos_f32 v224, v19
    v_sin_f32 v225, v19
    s_nop 0
    v_mul_f32 v224, v224, v18
    v_mul_f32 v225, v225, v18
    v_mul_f32 v18, v6, v14
    v_mul_f32 v19, v6, v15
    v_exp_f32 v18, v18
    v_fract_f32 v19, v19
    s_nop 0
    v_cos_f32 v226, v19
    v_sin_f32 v227, v19
    s_nop 0
    v_mul_f32 v226, v226, v18
    v_mul_f32 v227, v227, v18
    v_mul_f32 v18, v234, v234
    v_fmac_f32 v18, v235, v235
    v_rcp_f32 v18, v18
    v_add_f32 v19, -1.0, v212
    v_mul_f32 v214, v19, v234
    v_fmac_f32 v214, v213, v235
    v_mul_f32_e64 v215, v213, v234
    v_fma_f32 v215, -v19, v235, v215
    v_add_f32 v18, v18, v18
    v_mul_f32 v214, v214, v18
    v_mul_f32_e64 v215, v215, v18
    s_mul_i32 s31, s3, 1536
    s_add_u32 s31, s31, 148480
    v_lshlrev_b32_e64 v2, 5, v16
    v_add_u32 v4, 154624, v2
    v_add_u32_e64 v2, s31, v2
    v_lshl_add_u32 v3, v17, 3, v2
    s_lshl_b32 s31, s3, 3
    v_add_u32 v5, s31, v4
    v_lshlrev_b32_e64 v6, 4, v16
    s_mul_i32 s31, s3, 11520
    s_add_u32 s31, s31, 102400
    v_mul_u32_u24 v7, 144, v16
    v_lshl_add_u32 v7, v17, 5, v7
    v_add_u32 v7, s31, v7
    v_lshrrev_b32 v14, 3, v16
    v_mul_u32_u24 v14, 4608, v14
    v_add_u32 v14, 4608, v14
    v_add_u32_e64 v14, v14, v7
    v_bfe_u32 v15, v1, 2, 2
    v_mul_u32_u24 v15, 144, v15
    v_lshl_add_u32 v15, v17, 5, v15
    v_and_b32_e64 v18, 3, v1
    v_lshl_add_u32 v15, v18, 3, v15
    v_add_u32_e64 v15, s31, v15
    v_mul_u32_u24 v18, 40960, v17
    v_lshl_add_u32 v18, v16, 4, v18
    s_lshl_b32 s31, s20, 4
    s_lshl_b32 s69, s3, 2
    s_add_u32 s31, s31, s69
    s_mul_i32 s31, s31, 40960
    s_mul_i32 s69, s21, 1280
    s_add_u32 s31, s31, s69
    s_add_u32 s32, s31, 4194304
    s_add_u32 s33, s32, 20480
    v_and_b32 v19, 8, v16
    v_lshlrev_b32 v19, 12, v19
    v_lshl_or_b32 v19, v19, 16, v19
    v_lshlrev_b32_e64 v234, 3, v16
    v_add_u32 v234, 156160, v234
    s_lshl_b32 s31, s21, 3
    s_add_u32 s31, s31, s20
    s_mul_i32 s31, s31, 768
    s_add_u32 s34, s31, 16384
    v_cmp_eq_u32 s[74:75], 1, v17
    v_cmp_eq_u32 s[76:77], 2, v17
    v_cmp_eq_u32 s[36:37], 3, v17
    s_mov_b32 s27, 0
    s_mov_b32 s28, 49152
    s_mov_b32 s66, 49152
    s_mov_b32 s68, 0
    s_mov_b32 s24, 24576
    s_waitcnt lgkmcnt(0)
    s_add_u32 s72, s70, 1
    s_addc_u32 s73, s71, 0
    s_lshl_b32 s31, s3, 2
    v_add_u32 v252, s31, v253
    v_add_u32 v251, 8, v253
    L_f0B:
    ds_read_b64 v[74:75], v253
    s_waitcnt lgkmcnt(0)
    v_min_u32 v74, v74, v75
    s_nop 0
    v_readfirstlane_b32 s31, v74
    s_nop 3
    s_cmp_ge_u32 s31, 1
    s_cbranch_scc1 L_f1B
    s_sleep 1
    s_branch L_f0B
    L_f1B:
    ds_read_b128 v[20:23], v8 offset:0
    ds_read_b128 v[24:27], v8 offset:256
    ds_read_b128 v[28:31], v8 offset:512
    ds_read_b128 v[32:35], v8 offset:768
    ds_read_b128 v[52:55], v10 offset:0
    ds_read_b128 v[56:59], v11 offset:5120
    ds_read_b128 v[60:63], v10 offset:2048
    ds_read_b128 v[64:67], v11 offset:7168
    .p2align 3
L_loopB:
    s_waitcnt lgkmcnt(3)
    s_nop 0
    v_mfma_f32_16x16x32_bf16 v[84:87], v[20:23], v[52:55], v[84:87]
    ds_read_b128 v[68:71], v12
    v_mfma_f32_16x16x32_bf16 v[116:119], v[24:27], v[52:55], v[116:119]
    v_mfma_f32_16x16x32_bf16 v[148:151], v[28:31], v[52:55], v[148:151]
    v_mfma_f32_16x16x32_bf16 v[180:183], v[32:35], v[52:55], v[180:183]
    s_waitcnt lgkmcnt(3)
    s_nop 0
    v_mfma_f32_16x16x32_bf16 v[88:91], v[20:23], v[56:59], v[88:91]
    ds_read_b128 v[52:55], v11 offset:0
    v_mfma_f32_16x16x32_bf16 v[120:123], v[24:27], v[56:59], v[120:123]
    ds_read_b128 v[36:39], v9 offset:0
    v_mfma_f32_16x16x32_bf16 v[152:155], v[28:31], v[56:59], v[152:155]
    ds_read_b128 v[40:43], v9 offset:256
    v_mfma_f32_16x16x32_bf16 v[184:187], v[32:35], v[56:59], v[184:187]
    s_waitcnt lgkmcnt(5)
    s_nop 0
    v_mfma_f32_16x16x32_bf16 v[92:95], v[20:23], v[60:63], v[92:95]
    ds_read_b128 v[56:59], v10 offset:5120
    v_mfma_f32_16x16x32_bf16 v[124:127], v[24:27], v[60:63], v[124:127]
    ds_read_b128 v[44:47], v9 offset:512
    v_mfma_f32_16x16x32_bf16 v[156:159], v[28:31], v[60:63], v[156:159]
    ds_read_b128 v[48:51], v9 offset:768
    v_mfma_f32_16x16x32_bf16 v[188:191], v[32:35], v[60:63], v[188:191]
    s_add_u32 s27, s27, 1
    s_waitcnt lgkmcnt(7)
    v_mfma_f32_16x16x32_bf16 v[96:99], v[20:23], v[64:67], v[96:99]
    ds_read_b128 v[60:63], v11 offset:2048
    v_mfma_f32_16x16x32_bf16 v[128:131], v[24:27], v[64:67], v[128:131]
    v_add_u32 v8, s28, v8
    v_add_u32 v9, s28, v9
    v_mfma_f32_16x16x32_bf16 v[160:163], v[28:31], v[64:67], v[160:163]
    s_add_u32 s68, s68, 1
    s_cmp_eq_u32 s68, 3
    s_cselect_b32 s68, 0, s68
    s_nop 0
    v_mfma_f32_16x16x32_bf16 v[192:195], v[32:35], v[64:67], v[192:195]
    s_waitcnt lgkmcnt(7)
    s_nop 0
    v_mfma_f32_16x16x32_bf16 v[100:103], v[20:23], v[68:71], v[100:103]
    ds_read_b128 v[64:67], v10 offset:7168
    v_mfma_f32_16x16x32_bf16 v[132:135], v[24:27], v[68:71], v[132:135]
    s_cmp_eq_u32 s68, 2
    s_nop 0
    s_cselect_b32 s69, 4294868992, s66
    v_mfma_f32_16x16x32_bf16 v[164:167], v[28:31], v[68:71], v[164:167]
    v_mfma_f32_16x16x32_bf16 v[196:199], v[32:35], v[68:71], v[196:199]
    s_waitcnt lgkmcnt(2)
    s_nop 0
    v_mfma_f32_16x16x32_bf16 v[84:87], v[36:39], v[52:55], v[84:87]
    ds_read_b128 v[68:71], v13
    v_mfma_f32_16x16x32_bf16 v[116:119], v[40:43], v[52:55], v[116:119]
    v_add_u32_e64 v10, s28, v10
    v_mfma_f32_16x16x32_bf16 v[148:151], v[44:47], v[52:55], v[148:151]
    v_add_u32_e64 v11, s28, v11
    v_mfma_f32_16x16x32_bf16 v[180:183], v[48:51], v[52:55], v[180:183]
    v_mfma_f32_16x16x32_bf16 v[88:91], v[36:39], v[56:59], v[88:91]
    v_add_u32_e64 v12, s28, v12
    v_mfma_f32_16x16x32_bf16 v[120:123], v[40:43], v[56:59], v[120:123]
    v_add_u32_e64 v13, s28, v13
    v_mfma_f32_16x16x32_bf16 v[152:155], v[44:47], v[56:59], v[152:155]
    v_mfma_f32_16x16x32_bf16 v[184:187], v[48:51], v[56:59], v[184:187]
    ds_read_b64 v[20:21], v251
    v_mov_b32 v249, s27
    s_cmp_lt_u32 s27, 10
    s_cselect_b32 s23, s27, 0
    s_waitcnt lgkmcnt(3)
    v_mfma_f32_16x16x32_bf16 v[92:95], v[36:39], v[60:63], v[92:95]
    v_mfma_f32_16x16x32_bf16 v[124:127], v[40:43], v[60:63], v[124:127]
    v_mfma_f32_16x16x32_bf16 v[156:159], v[44:47], v[60:63], v[156:159]
    v_mfma_f32_16x16x32_bf16 v[188:191], v[48:51], v[60:63], v[188:191]
    s_waitcnt lgkmcnt(0)
    v_min_u32 v20, v20, v21
    ds_write_b32 v252, v249 offset:16
    v_readfirstlane_b32 s31, v20
    s_nop 1
    s_cmp_gt_u32 s31, s23
    s_cbranch_scc1 L_fkB
    L_fwB:
    ds_read_b64 v[20:21], v251
    s_waitcnt lgkmcnt(0)
    v_min_u32 v20, v20, v21
    ds_write_b32 v252, v249 offset:16
    v_readfirstlane_b32 s31, v20
    s_nop 1
    s_cmp_gt_u32 s31, s23
    s_cbranch_scc0 L_fwB
    L_fkB:
    v_xor_b32_e64 v251, 8, v251
    v_mfma_f32_16x16x32_bf16 v[96:99], v[36:39], v[64:67], v[96:99]
    ds_read_b128 v[20:23], v8 offset:0
    v_mfma_f32_16x16x32_bf16 v[128:131], v[40:43], v[64:67], v[128:131]
    ds_read_b128 v[24:27], v8 offset:256
    v_mfma_f32_16x16x32_bf16 v[160:163], v[44:47], v[64:67], v[160:163]
    ds_read_b128 v[28:31], v8 offset:512
    v_mfma_f32_16x16x32_bf16 v[192:195], v[48:51], v[64:67], v[192:195]
    ds_read_b128 v[32:35], v8 offset:768
    v_mfma_f32_16x16x32_bf16 v[100:103], v[36:39], v[68:71], v[100:103]
    ds_read_b128 v[52:55], v10 offset:0
    v_mfma_f32_16x16x32_bf16 v[132:135], v[40:43], v[68:71], v[132:135]
    ds_read_b128 v[56:59], v11 offset:5120
    v_mfma_f32_16x16x32_bf16 v[164:167], v[44:47], v[68:71], v[164:167]
    ds_read_b128 v[60:63], v10 offset:2048
    v_mfma_f32_16x16x32_bf16 v[196:199], v[48:51], v[68:71], v[196:199]
    ds_read_b128 v[64:67], v11 offset:7168
    s_mov_b32 s28, s69
    s_sub_u32 s24, 0, s24
    s_cmp_lt_u32 s27, 10
    s_cbranch_scc1 L_loopB
    s_waitcnt lgkmcnt(0)
    s_nop 6
    v_mov_b32_dpp v104, v100 row_ror:8 row_mask:0xf bank_mask:0xf
    v_mov_b32_dpp v105, v101 row_ror:8 row_mask:0xf bank_mask:0xf
    v_mov_b32_dpp v106, v102 row_ror:8 row_mask:0xf bank_mask:0xf
    v_mov_b32_dpp v107, v103 row_ror:8 row_mask:0xf bank_mask:0xf
    v_mov_b32_dpp v136, v132 row_ror:8 row_mask:0xf bank_mask:0xf
    v_mov_b32_dpp v137, v133 row_ror:8 row_mask:0xf bank_mask:0xf
    v_mov_b32_dpp v138, v134 row_ror:8 row_mask:0xf bank_mask:0xf
    v_mov_b32_dpp v139, v135 row_ror:8 row_mask:0xf bank_mask:0xf
    v_mov_b32_dpp v168, v164 row_ror:8 row_mask:0xf bank_mask:0xf
    v_mov_b32_dpp v169, v165 row_ror:8 row_mask:0xf bank_mask:0xf
    v_mov_b32_dpp v170, v166 row_ror:8 row_mask:0xf bank_mask:0xf
    v_mov_b32_dpp v171, v167 row_ror:8 row_mask:0xf bank_mask:0xf
    v_mov_b32_dpp v200, v196 row_ror:8 row_mask:0xf bank_mask:0xf
    v_mov_b32_dpp v201, v197 row_ror:8 row_mask:0xf bank_mask:0xf
    v_mov_b32_dpp v202, v198 row_ror:8 row_mask:0xf bank_mask:0xf
    v_mov_b32_dpp v203, v199 row_ror:8 row_mask:0xf bank_mask:0xf
    v_pk_fma_f32 v[24:25], v[84:85], v[108:109], v[86:87] op_sel:[0,0,0] op_sel_hi:[1,0,1]
    v_pk_fma_f32 v[26:27], v[88:89], v[108:109], v[90:91] op_sel:[0,0,0] op_sel_hi:[1,0,1]
    v_pk_fma_f32 v[32:33], v[92:93], v[172:173], v[94:95] op_sel:[0,0,0] op_sel_hi:[1,0,1]
    v_pk_fma_f32 v[34:35], v[96:97], v[172:173], v[98:99] op_sel:[0,0,0] op_sel_hi:[1,0,1]
    v_pk_fma_f32 v[40:41], v[100:101], v[212:213], v[102:103] op_sel:[0,0,0] op_sel_hi:[1,0,1]
    v_pk_fma_f32 v[42:43], v[104:105], v[212:213], v[106:107] op_sel:[0,0,0] op_sel_hi:[1,0,1]
    v_pk_fma_f32 v[24:25], v[88:89], v[108:109], v[24:25] op_sel:[0,1,0] op_sel_hi:[1,1,1] neg_lo:[0,1,0] neg_hi:[0,1,0]
    v_pk_fma_f32 v[26:27], v[84:85], v[108:109], v[26:27] op_sel:[0,1,0] op_sel_hi:[1,1,1]
    v_pk_fma_f32 v[32:33], v[96:97], v[172:173], v[32:33] op_sel:[0,1,0] op_sel_hi:[1,1,1] neg_lo:[0,1,0] neg_hi:[0,1,0]
    v_pk_fma_f32 v[34:35], v[92:93], v[172:173], v[34:35] op_sel:[0,1,0] op_sel_hi:[1,1,1]
    v_pk_fma_f32 v[40:41], v[104:105], v[212:213], v[40:41] op_sel:[0,1,0] op_sel_hi:[1,1,1] neg_lo:[0,1,0] neg_hi:[0,1,0]
    v_pk_fma_f32 v[42:43], v[100:101], v[212:213], v[42:43] op_sel:[0,1,0] op_sel_hi:[1,1,1]
    v_pk_fma_f32 v[20:21], v[24:25], v[108:109], v[116:117] op_sel:[0,0,0] op_sel_hi:[1,0,1]
    v_pk_fma_f32 v[22:23], v[26:27], v[108:109], v[120:121] op_sel:[0,0,0] op_sel_hi:[1,0,1]
    v_pk_fma_f32 v[28:29], v[32:33], v[172:173], v[124:125] op_sel:[0,0,0] op_sel_hi:[1,0,1]
    v_pk_fma_f32 v[30:31], v[34:35], v[172:173], v[128:129] op_sel:[0,0,0] op_sel_hi:[1,0,1]
    v_pk_fma_f32 v[36:37], v[40:41], v[212:213], v[132:133] op_sel:[0,0,0] op_sel_hi:[1,0,1]
    v_pk_fma_f32 v[38:39], v[42:43], v[212:213], v[136:137] op_sel:[0,0,0] op_sel_hi:[1,0,1]
    v_pk_fma_f32 v[20:21], v[26:27], v[108:109], v[20:21] op_sel:[0,1,0] op_sel_hi:[1,1,1] neg_lo:[0,1,0] neg_hi:[0,1,0]
    v_pk_fma_f32 v[22:23], v[24:25], v[108:109], v[22:23] op_sel:[0,1,0] op_sel_hi:[1,1,1]
    v_pk_fma_f32 v[28:29], v[34:35], v[172:173], v[28:29] op_sel:[0,1,0] op_sel_hi:[1,1,1] neg_lo:[0,1,0] neg_hi:[0,1,0]
    v_pk_fma_f32 v[30:31], v[32:33], v[172:173], v[30:31] op_sel:[0,1,0] op_sel_hi:[1,1,1]
    v_pk_fma_f32 v[36:37], v[42:43], v[212:213], v[36:37] op_sel:[0,1,0] op_sel_hi:[1,1,1] neg_lo:[0,1,0] neg_hi:[0,1,0]
    v_pk_fma_f32 v[38:39], v[40:41], v[212:213], v[38:39] op_sel:[0,1,0] op_sel_hi:[1,1,1]
    v_pk_fma_f32 v[24:25], v[20:21], v[108:109], v[118:119] op_sel:[0,0,0] op_sel_hi:[1,0,1]
    v_pk_fma_f32 v[26:27], v[22:23], v[108:109], v[122:123] op_sel:[0,0,0] op_sel_hi:[1,0,1]
    v_pk_fma_f32 v[32:33], v[28:29], v[172:173], v[126:127] op_sel:[0,0,0] op_sel_hi:[1,0,1]
    v_pk_fma_f32 v[34:35], v[30:31], v[172:173], v[130:131] op_sel:[0,0,0] op_sel_hi:[1,0,1]
    v_pk_fma_f32 v[40:41], v[36:37], v[212:213], v[134:135] op_sel:[0,0,0] op_sel_hi:[1,0,1]
    v_pk_fma_f32 v[42:43], v[38:39], v[212:213], v[138:139] op_sel:[0,0,0] op_sel_hi:[1,0,1]
    v_pk_fma_f32 v[24:25], v[22:23], v[108:109], v[24:25] op_sel:[0,1,0] op_sel_hi:[1,1,1] neg_lo:[0,1,0] neg_hi:[0,1,0]
    v_pk_fma_f32 v[26:27], v[20:21], v[108:109], v[26:27] op_sel:[0,1,0] op_sel_hi:[1,1,1]
    v_pk_fma_f32 v[32:33], v[30:31], v[172:173], v[32:33] op_sel:[0,1,0] op_sel_hi:[1,1,1] neg_lo:[0,1,0] neg_hi:[0,1,0]
    v_pk_fma_f32 v[34:35], v[28:29], v[172:173], v[34:35] op_sel:[0,1,0] op_sel_hi:[1,1,1]
    v_pk_fma_f32 v[40:41], v[38:39], v[212:213], v[40:41] op_sel:[0,1,0] op_sel_hi:[1,1,1] neg_lo:[0,1,0] neg_hi:[0,1,0]
    v_pk_fma_f32 v[42:43], v[36:37], v[212:213], v[42:43] op_sel:[0,1,0] op_sel_hi:[1,1,1]
    v_pk_fma_f32 v[20:21], v[24:25], v[108:109], v[148:149] op_sel:[0,0,0] op_sel_hi:[1,0,1]
    v_pk_fma_f32 v[22:23], v[26:27], v[108:109], v[152:153] op_sel:[0,0,0] op_sel_hi:[1,0,1]
    v_pk_fma_f32 v[28:29], v[32:33], v[172:173], v[156:157] op_sel:[0,0,0] op_sel_hi:[1,0,1]
    v_pk_fma_f32 v[30:31], v[34:35], v[172:173], v[160:161] op_sel:[0,0,0] op_sel_hi:[1,0,1]
    v_pk_fma_f32 v[36:37], v[40:41], v[212:213], v[164:165] op_sel:[0,0,0] op_sel_hi:[1,0,1]
    v_pk_fma_f32 v[38:39], v[42:43], v[212:213], v[168:169] op_sel:[0,0,0] op_sel_hi:[1,0,1]
    v_pk_fma_f32 v[20:21], v[26:27], v[108:109], v[20:21] op_sel:[0,1,0] op_sel_hi:[1,1,1] neg_lo:[0,1,0] neg_hi:[0,1,0]
    v_pk_fma_f32 v[22:23], v[24:25], v[108:109], v[22:23] op_sel:[0,1,0] op_sel_hi:[1,1,1]
    v_pk_fma_f32 v[28:29], v[34:35], v[172:173], v[28:29] op_sel:[0,1,0] op_sel_hi:[1,1,1] neg_lo:[0,1,0] neg_hi:[0,1,0]
    v_pk_fma_f32 v[30:31], v[32:33], v[172:173], v[30:31] op_sel:[0,1,0] op_sel_hi:[1,1,1]
    v_pk_fma_f32 v[36:37], v[42:43], v[212:213], v[36:37] op_sel:[0,1,0] op_sel_hi:[1,1,1] neg_lo:[0,1,0] neg_hi:[0,1,0]
    v_pk_fma_f32 v[38:39], v[40:41], v[212:213], v[38:39] op_sel:[0,1,0] op_sel_hi:[1,1,1]
    v_pk_fma_f32 v[24:25], v[20:21], v[108:109], v[150:151] op_sel:[0,0,0] op_sel_hi:[1,0,1]
    v_pk_fma_f32 v[26:27], v[22:23], v[108:109], v[154:155] op_sel:[0,0,0] op_sel_hi:[1,0,1]
    v_pk_fma_f32 v[32:33], v[28:29], v[172:173], v[158:159] op_sel:[0,0,0] op_sel_hi:[1,0,1]
    v_pk_fma_f32 v[34:35], v[30:31], v[172:173], v[162:163] op_sel:[0,0,0] op_sel_hi:[1,0,1]
    v_pk_fma_f32 v[40:41], v[36:37], v[212:213], v[166:167] op_sel:[0,0,0] op_sel_hi:[1,0,1]
    v_pk_fma_f32 v[42:43], v[38:39], v[212:213], v[170:171] op_sel:[0,0,0] op_sel_hi:[1,0,1]
    v_pk_fma_f32 v[24:25], v[22:23], v[108:109], v[24:25] op_sel:[0,1,0] op_sel_hi:[1,1,1] neg_lo:[0,1,0] neg_hi:[0,1,0]
    v_pk_fma_f32 v[26:27], v[20:21], v[108:109], v[26:27] op_sel:[0,1,0] op_sel_hi:[1,1,1]
    v_pk_fma_f32 v[32:33], v[30:31], v[172:173], v[32:33] op_sel:[0,1,0] op_sel_hi:[1,1,1] neg_lo:[0,1,0] neg_hi:[0,1,0]
    v_pk_fma_f32 v[34:35], v[28:29], v[172:173], v[34:35] op_sel:[0,1,0] op_sel_hi:[1,1,1]
    v_pk_fma_f32 v[40:41], v[38:39], v[212:213], v[40:41] op_sel:[0,1,0] op_sel_hi:[1,1,1] neg_lo:[0,1,0] neg_hi:[0,1,0]
    v_pk_fma_f32 v[42:43], v[36:37], v[212:213], v[42:43] op_sel:[0,1,0] op_sel_hi:[1,1,1]
    v_pk_fma_f32 v[20:21], v[24:25], v[108:109], v[180:181] op_sel:[0,0,0] op_sel_hi:[1,0,1]
    v_pk_fma_f32 v[22:23], v[26:27], v[108:109], v[184:185] op_sel:[0,0,0] op_sel_hi:[1,0,1]
    v_pk_fma_f32 v[28:29], v[32:33], v[172:173], v[188:189] op_sel:[0,0,0] op_sel_hi:[1,0,1]
    v_pk_fma_f32 v[30:31], v[34:35], v[172:173], v[192:193] op_sel:[0,0,0] op_sel_hi:[1,0,1]
    v_pk_fma_f32 v[36:37], v[40:41], v[212:213], v[196:197] op_sel:[0,0,0] op_sel_hi:[1,0,1]
    v_pk_fma_f32 v[38:39], v[42:43], v[212:213], v[200:201] op_sel:[0,0,0] op_sel_hi:[1,0,1]
    v_pk_fma_f32 v[20:21], v[26:27], v[108:109], v[20:21] op_sel:[0,1,0] op_sel_hi:[1,1,1] neg_lo:[0,1,0] neg_hi:[0,1,0]
    v_pk_fma_f32 v[22:23], v[24:25], v[108:109], v[22:23] op_sel:[0,1,0] op_sel_hi:[1,1,1]
    v_pk_fma_f32 v[28:29], v[34:35], v[172:173], v[28:29] op_sel:[0,1,0] op_sel_hi:[1,1,1] neg_lo:[0,1,0] neg_hi:[0,1,0]
    v_pk_fma_f32 v[30:31], v[32:33], v[172:173], v[30:31] op_sel:[0,1,0] op_sel_hi:[1,1,1]
    v_pk_fma_f32 v[36:37], v[42:43], v[212:213], v[36:37] op_sel:[0,1,0] op_sel_hi:[1,1,1] neg_lo:[0,1,0] neg_hi:[0,1,0]
    v_pk_fma_f32 v[38:39], v[40:41], v[212:213], v[38:39] op_sel:[0,1,0] op_sel_hi:[1,1,1]
    v_pk_fma_f32 v[24:25], v[20:21], v[108:109], v[182:183] op_sel:[0,0,0] op_sel_hi:[1,0,1]
    v_pk_fma_f32 v[26:27], v[22:23], v[108:109], v[186:187] op_sel:[0,0,0] op_sel_hi:[1,0,1]
    v_pk_fma_f32 v[32:33], v[28:29], v[172:173], v[190:191] op_sel:[0,0,0] op_sel_hi:[1,0,1]
    v_pk_fma_f32 v[34:35], v[30:31], v[172:173], v[194:195] op_sel:[0,0,0] op_sel_hi:[1,0,1]
    v_pk_fma_f32 v[40:41], v[36:37], v[212:213], v[198:199] op_sel:[0,0,0] op_sel_hi:[1,0,1]
    v_pk_fma_f32 v[42:43], v[38:39], v[212:213], v[202:203] op_sel:[0,0,0] op_sel_hi:[1,0,1]
    v_pk_fma_f32 v[24:25], v[22:23], v[108:109], v[24:25] op_sel:[0,1,0] op_sel_hi:[1,1,1] neg_lo:[0,1,0] neg_hi:[0,1,0]
    v_pk_fma_f32 v[26:27], v[20:21], v[108:109], v[26:27] op_sel:[0,1,0] op_sel_hi:[1,1,1]
    v_pk_fma_f32 v[32:33], v[30:31], v[172:173], v[32:33] op_sel:[0,1,0] op_sel_hi:[1,1,1] neg_lo:[0,1,0] neg_hi:[0,1,0]
    v_pk_fma_f32 v[34:35], v[28:29], v[172:173], v[34:35] op_sel:[0,1,0] op_sel_hi:[1,1,1]
    v_pk_fma_f32 v[40:41], v[38:39], v[212:213], v[40:41] op_sel:[0,1,0] op_sel_hi:[1,1,1] neg_lo:[0,1,0] neg_hi:[0,1,0]
    v_pk_fma_f32 v[42:43], v[36:37], v[212:213], v[42:43] op_sel:[0,1,0] op_sel_hi:[1,1,1]
    v_fma_f32 v44, v24, v112, v25
    v_fma_f32 v45, v26, v112, v27
    v_fma_f32 v46, v32, v176, v33
    v_fma_f32 v47, v34, v176, v35
    v_fma_f32 v48, v40, v216, v41
    v_fma_f32 v49, v42, v216, v43
    v_fma_f32 v44, -v26, v113, v44
    v_fma_f32 v45, v24, v113, v45
    v_fma_f32 v46, -v34, v177, v46
    v_fma_f32 v47, v32, v177, v47
    v_fma_f32 v48, -v42, v217, v48
    v_fma_f32 v49, v40, v217, v49
    ds_write_b64 v3, v[44:45] offset:0
    ds_write_b64 v3, v[46:47] offset:512
    ds_write_b64 v3, v[48:49] offset:1024
    ds_read_b128 v[52:55], v2 offset:0
    ds_read_b128 v[56:59], v2 offset:16
    ds_read_b128 v[60:63], v2 offset:512
    ds_read_b128 v[64:67], v2 offset:528
    ds_read_b128 v[68:71], v2 offset:1024
    ds_read_b128 v[72:75], v2 offset:1040
    s_waitcnt lgkmcnt(0)
    v_fma_f32 v54, v52, v114, v54
    v_fma_f32 v55, v53, v114, v55
    v_fma_f32 v62, v60, v178, v62
    v_fma_f32 v63, v61, v178, v63
    v_fma_f32 v70, v68, v218, v70
    v_fma_f32 v71, v69, v218, v71
    v_fma_f32 v54, -v53, v115, v54
    v_fma_f32 v55, v52, v115, v55
    v_fma_f32 v62, -v61, v179, v62
    v_fma_f32 v63, v60, v179, v63
    v_fma_f32 v70, -v69, v219, v70
    v_fma_f32 v71, v68, v219, v71
    v_fma_f32 v56, v54, v114, v56
    v_fma_f32 v57, v55, v114, v57
    v_fma_f32 v64, v62, v178, v64
    v_fma_f32 v65, v63, v178, v65
    v_fma_f32 v72, v70, v218, v72
    v_fma_f32 v73, v71, v218, v73
    v_fma_f32 v56, -v55, v115, v56
    v_fma_f32 v57, v54, v115, v57
    v_fma_f32 v64, -v63, v179, v64
    v_fma_f32 v65, v62, v179, v65
    v_fma_f32 v72, -v71, v219, v72
    v_fma_f32 v73, v70, v219, v73
    v_fma_f32 v58, v56, v114, v58
    v_fma_f32 v59, v57, v114, v59
    v_fma_f32 v66, v64, v178, v66
    v_fma_f32 v67, v65, v178, v67
    v_fma_f32 v74, v72, v218, v74
    v_fma_f32 v75, v73, v218, v75
    v_fma_f32 v58, -v57, v115, v58
    v_fma_f32 v59, v56, v115, v59
    v_fma_f32 v66, -v65, v179, v66
    v_fma_f32 v67, v64, v179, v67
    v_fma_f32 v74, -v73, v219, v74
    v_fma_f32 v75, v72, v219, v75
    ds_write_b64 v5, v[58:59] offset:0
    ds_write_b64 v5, v[66:67] offset:512
    ds_write_b64 v5, v[74:75] offset:1024
    v_cndmask_b32 v228, 0, v52, s[74:75]
    v_cndmask_b32 v228, v228, v54, s[76:77]
    v_cndmask_b32 v228, v228, v56, s[36:37]
    v_cndmask_b32 v229, 0, v53, s[74:75]
    v_cndmask_b32 v229, v229, v55, s[76:77]
    v_cndmask_b32 v229, v229, v57, s[36:37]
    v_cndmask_b32 v230, 0, v60, s[74:75]
    v_cndmask_b32 v230, v230, v62, s[76:77]
    v_cndmask_b32 v230, v230, v64, s[36:37]
    v_cndmask_b32 v231, 0, v61, s[74:75]
    v_cndmask_b32 v231, v231, v63, s[76:77]
    v_cndmask_b32 v231, v231, v65, s[36:37]
    v_cndmask_b32 v232, 0, v68, s[74:75]
    v_cndmask_b32 v232, v232, v70, s[76:77]
    v_cndmask_b32 v232, v232, v72, s[36:37]
    v_cndmask_b32 v233, 0, v69, s[74:75]
    v_cndmask_b32 v233, v233, v71, s[76:77]
    v_cndmask_b32 v233, v233, v73, s[36:37]
    s_waitcnt lgkmcnt(0)
    s_barrier
    ds_read_b128 v[52:55], v4 offset:0
    ds_read_b128 v[56:59], v4 offset:16
    ds_read_b128 v[60:63], v4 offset:512
    ds_read_b128 v[64:67], v4 offset:528
    ds_read_b128 v[68:71], v4 offset:1024
    ds_read_b128 v[72:75], v4 offset:1040
    s_cmp_eq_u32 s3, 1
    s_cselect_b64 s[74:75], -1, 0
    s_cmp_eq_u32 s3, 2
    s_cselect_b64 s[76:77], -1, 0
    s_cmp_eq_u32 s3, 3
    s_cselect_b64 s[36:37], -1, 0
    v_mov_b32 v242, s72
    v_mov_b32 v243, s73
    v_mov_b32 v246, s72
    v_mov_b32 v247, s73
    v_mov_b32 v250, s72
    v_mov_b32 v251, s73
    s_waitcnt lgkmcnt(0)
    v_fma_f32 v54, v52, v140, v54
    v_fma_f32 v55, v53, v140, v55
    v_fma_f32 v62, v60, v204, v62
    v_fma_f32 v63, v61, v204, v63
    v_fma_f32 v70, v68, v220, v70
    v_fma_f32 v71, v69, v220, v71
    v_fma_f32 v54, -v53, v141, v54
    v_fma_f32 v55, v52, v141, v55
    v_fma_f32 v62, -v61, v205, v62
    v_fma_f32 v63, v60, v205, v63
    v_fma_f32 v70, -v69, v221, v70
    v_fma_f32 v71, v68, v221, v71
    v_fma_f32 v56, v54, v140, v56
    v_fma_f32 v57, v55, v140, v57
    v_fma_f32 v64, v62, v204, v64
    v_fma_f32 v65, v63, v204, v65
    v_fma_f32 v72, v70, v220, v72
    v_fma_f32 v73, v71, v220, v73
    v_fma_f32 v56, -v55, v141, v56
    v_fma_f32 v57, v54, v141, v57
    v_fma_f32 v64, -v63, v205, v64
    v_fma_f32 v65, v62, v205, v65
    v_fma_f32 v72, -v71, v221, v72
    v_fma_f32 v73, v70, v221, v73
    v_fma_f32 v240, v56, v140, v58
    v_fma_f32 v241, v57, v140, v59
    v_fma_f32 v244, v64, v204, v66
    v_fma_f32 v245, v65, v204, v67
    v_fma_f32 v248, v72, v220, v74
    v_fma_f32 v249, v73, v220, v75
    v_fma_f32 v240, -v57, v141, v240
    v_fma_f32 v241, v56, v141, v241
    v_fma_f32 v244, -v65, v205, v244
    v_fma_f32 v245, v64, v205, v245
    v_fma_f32 v248, -v73, v221, v248
    v_fma_f32 v249, v72, v221, v249
    s_cmp_eq_u32 s3, 0
    s_cbranch_scc0 L_B_nopub
    s_mov_b64 exec, 0xffff
    buffer_store_dwordx4 v[240:243], v6, s[12:15], s34 offen offset:0 sc1
    buffer_store_dwordx4 v[244:247], v6, s[12:15], s34 offen offset:256 sc1
    buffer_store_dwordx4 v[248:251], v6, s[12:15], s34 offen offset:512 sc1
    s_mov_b64 exec, -1
L_B_nopub:
    v_cndmask_b32 v58, 0, v52, s[74:75]
    v_cndmask_b32 v58, v58, v54, s[76:77]
    v_cndmask_b32 v58, v58, v56, s[36:37]
    v_cndmask_b32 v59, 0, v53, s[74:75]
    v_cndmask_b32 v59, v59, v55, s[76:77]
    v_cndmask_b32 v59, v59, v57, s[36:37]
    v_cndmask_b32 v66, 0, v60, s[74:75]
    v_cndmask_b32 v66, v66, v62, s[76:77]
    v_cndmask_b32 v66, v66, v64, s[36:37]
    v_cndmask_b32 v67, 0, v61, s[74:75]
    v_cndmask_b32 v67, v67, v63, s[76:77]
    v_cndmask_b32 v67, v67, v65, s[36:37]
    v_cndmask_b32 v74, 0, v68, s[74:75]
    v_cndmask_b32 v74, v74, v70, s[76:77]
    v_cndmask_b32 v74, v74, v72, s[36:37]
    v_cndmask_b32 v75, 0, v69, s[74:75]
    v_cndmask_b32 v75, v75, v71, s[76:77]
    v_cndmask_b32 v75, v75, v73, s[36:37]
    v_fma_f32 v228, v58, v144, v228
    v_fma_f32 v229, v59, v144, v229
    v_fma_f32 v230, v66, v208, v230
    v_fma_f32 v231, v67, v208, v231
    v_fma_f32 v232, v74, v224, v232
    v_fma_f32 v233, v75, v224, v233
    v_fma_f32 v228, -v59, v145, v228
    v_fma_f32 v229, v58, v145, v229
    v_fma_f32 v230, -v67, v209, v230
    v_fma_f32 v231, v66, v209, v231
    v_fma_f32 v232, -v75, v225, v232
    v_fma_f32 v233, v74, v225, v233
    v_pk_mul_f32 v[236:237], v[84:85], v[110:111] op_sel:[0,1] op_sel_hi:[1,1]
    v_pk_mul_f32 v[84:85], v[84:85], v[110:111] op_sel:[0,0] op_sel_hi:[1,0]
    v_pk_mul_f32 v[238:239], v[86:87], v[110:111] op_sel:[0,1] op_sel_hi:[1,1]
    v_pk_mul_f32 v[86:87], v[86:87], v[110:111] op_sel:[0,0] op_sel_hi:[1,0]
    v_pk_fma_f32 v[84:85], v[88:89], v[110:111], v[84:85] op_sel:[0,1,0] op_sel_hi:[1,1,1] neg_lo:[0,1,0] neg_hi:[0,1,0]
    v_pk_fma_f32 v[88:89], v[88:89], v[110:111], v[236:237] op_sel:[0,0,0] op_sel_hi:[1,0,1]
    v_pk_fma_f32 v[86:87], v[90:91], v[110:111], v[86:87] op_sel:[0,1,0] op_sel_hi:[1,1,1] neg_lo:[0,1,0] neg_hi:[0,1,0]
    v_pk_fma_f32 v[90:91], v[90:91], v[110:111], v[238:239] op_sel:[0,0,0] op_sel_hi:[1,0,1]
    v_pk_mul_f32 v[236:237], v[116:117], v[110:111] op_sel:[0,1] op_sel_hi:[1,1]
    v_pk_mul_f32 v[116:117], v[116:117], v[110:111] op_sel:[0,0] op_sel_hi:[1,0]
    v_pk_mul_f32 v[238:239], v[118:119], v[110:111] op_sel:[0,1] op_sel_hi:[1,1]
    v_pk_mul_f32 v[118:119], v[118:119], v[110:111] op_sel:[0,0] op_sel_hi:[1,0]
    v_pk_fma_f32 v[116:117], v[120:121], v[110:111], v[116:117] op_sel:[0,1,0] op_sel_hi:[1,1,1] neg_lo:[0,1,0] neg_hi:[0,1,0]
    v_pk_fma_f32 v[120:121], v[120:121], v[110:111], v[236:237] op_sel:[0,0,0] op_sel_hi:[1,0,1]
    v_pk_fma_f32 v[118:119], v[122:123], v[110:111], v[118:119] op_sel:[0,1,0] op_sel_hi:[1,1,1] neg_lo:[0,1,0] neg_hi:[0,1,0]
    v_pk_fma_f32 v[122:123], v[122:123], v[110:111], v[238:239] op_sel:[0,0,0] op_sel_hi:[1,0,1]
    v_pk_mul_f32 v[236:237], v[148:149], v[110:111] op_sel:[0,1] op_sel_hi:[1,1]
    v_pk_mul_f32 v[148:149], v[148:149], v[110:111] op_sel:[0,0] op_sel_hi:[1,0]
    v_pk_mul_f32 v[238:239], v[150:151], v[110:111] op_sel:[0,1] op_sel_hi:[1,1]
    v_pk_mul_f32 v[150:151], v[150:151], v[110:111] op_sel:[0,0] op_sel_hi:[1,0]
    v_pk_fma_f32 v[148:149], v[152:153], v[110:111], v[148:149] op_sel:[0,1,0] op_sel_hi:[1,1,1] neg_lo:[0,1,0] neg_hi:[0,1,0]
    v_pk_fma_f32 v[152:153], v[152:153], v[110:111], v[236:237] op_sel:[0,0,0] op_sel_hi:[1,0,1]
    v_pk_fma_f32 v[150:151], v[154:155], v[110:111], v[150:151] op_sel:[0,1,0] op_sel_hi:[1,1,1] neg_lo:[0,1,0] neg_hi:[0,1,0]
    v_pk_fma_f32 v[154:155], v[154:155], v[110:111], v[238:239] op_sel:[0,0,0] op_sel_hi:[1,0,1]
    v_pk_mul_f32 v[236:237], v[180:181], v[110:111] op_sel:[0,1] op_sel_hi:[1,1]
    v_pk_mul_f32 v[180:181], v[180:181], v[110:111] op_sel:[0,0] op_sel_hi:[1,0]
    v_pk_mul_f32 v[238:239], v[182:183], v[110:111] op_sel:[0,1] op_sel_hi:[1,1]
    v_pk_mul_f32 v[182:183], v[182:183], v[110:111] op_sel:[0,0] op_sel_hi:[1,0]
    v_pk_fma_f32 v[180:181], v[184:185], v[110:111], v[180:181] op_sel:[0,1,0] op_sel_hi:[1,1,1] neg_lo:[0,1,0] neg_hi:[0,1,0]
    v_pk_fma_f32 v[184:185], v[184:185], v[110:111], v[236:237] op_sel:[0,0,0] op_sel_hi:[1,0,1]
    v_pk_fma_f32 v[182:183], v[186:187], v[110:111], v[182:183] op_sel:[0,1,0] op_sel_hi:[1,1,1] neg_lo:[0,1,0] neg_hi:[0,1,0]
    v_pk_fma_f32 v[186:187], v[186:187], v[110:111], v[238:239] op_sel:[0,0,0] op_sel_hi:[1,0,1]
    v_pk_mul_f32 v[236:237], v[92:93], v[174:175] op_sel:[0,1] op_sel_hi:[1,1]
    v_pk_mul_f32 v[92:93], v[92:93], v[174:175] op_sel:[0,0] op_sel_hi:[1,0]
    v_pk_mul_f32 v[238:239], v[94:95], v[174:175] op_sel:[0,1] op_sel_hi:[1,1]
    v_pk_mul_f32 v[94:95], v[94:95], v[174:175] op_sel:[0,0] op_sel_hi:[1,0]
    v_pk_fma_f32 v[92:93], v[96:97], v[174:175], v[92:93] op_sel:[0,1,0] op_sel_hi:[1,1,1] neg_lo:[0,1,0] neg_hi:[0,1,0]
    v_pk_fma_f32 v[96:97], v[96:97], v[174:175], v[236:237] op_sel:[0,0,0] op_sel_hi:[1,0,1]
    v_pk_fma_f32 v[94:95], v[98:99], v[174:175], v[94:95] op_sel:[0,1,0] op_sel_hi:[1,1,1] neg_lo:[0,1,0] neg_hi:[0,1,0]
    v_pk_fma_f32 v[98:99], v[98:99], v[174:175], v[238:239] op_sel:[0,0,0] op_sel_hi:[1,0,1]
    v_pk_mul_f32 v[236:237], v[124:125], v[174:175] op_sel:[0,1] op_sel_hi:[1,1]
    v_pk_mul_f32 v[124:125], v[124:125], v[174:175] op_sel:[0,0] op_sel_hi:[1,0]
    v_pk_mul_f32 v[238:239], v[126:127], v[174:175] op_sel:[0,1] op_sel_hi:[1,1]
    v_pk_mul_f32 v[126:127], v[126:127], v[174:175] op_sel:[0,0] op_sel_hi:[1,0]
    v_pk_fma_f32 v[124:125], v[128:129], v[174:175], v[124:125] op_sel:[0,1,0] op_sel_hi:[1,1,1] neg_lo:[0,1,0] neg_hi:[0,1,0]
    v_pk_fma_f32 v[128:129], v[128:129], v[174:175], v[236:237] op_sel:[0,0,0] op_sel_hi:[1,0,1]
    v_pk_fma_f32 v[126:127], v[130:131], v[174:175], v[126:127] op_sel:[0,1,0] op_sel_hi:[1,1,1] neg_lo:[0,1,0] neg_hi:[0,1,0]
    v_pk_fma_f32 v[130:131], v[130:131], v[174:175], v[238:239] op_sel:[0,0,0] op_sel_hi:[1,0,1]
    v_pk_mul_f32 v[236:237], v[156:157], v[174:175] op_sel:[0,1] op_sel_hi:[1,1]
    v_pk_mul_f32 v[156:157], v[156:157], v[174:175] op_sel:[0,0] op_sel_hi:[1,0]
    v_pk_mul_f32 v[238:239], v[158:159], v[174:175] op_sel:[0,1] op_sel_hi:[1,1]
    v_pk_mul_f32 v[158:159], v[158:159], v[174:175] op_sel:[0,0] op_sel_hi:[1,0]
    v_pk_fma_f32 v[156:157], v[160:161], v[174:175], v[156:157] op_sel:[0,1,0] op_sel_hi:[1,1,1] neg_lo:[0,1,0] neg_hi:[0,1,0]
    v_pk_fma_f32 v[160:161], v[160:161], v[174:175], v[236:237] op_sel:[0,0,0] op_sel_hi:[1,0,1]
    v_pk_fma_f32 v[158:159], v[162:163], v[174:175], v[158:159] op_sel:[0,1,0] op_sel_hi:[1,1,1] neg_lo:[0,1,0] neg_hi:[0,1,0]
    v_pk_fma_f32 v[162:163], v[162:163], v[174:175], v[238:239] op_sel:[0,0,0] op_sel_hi:[1,0,1]
    v_pk_mul_f32 v[236:237], v[188:189], v[174:175] op_sel:[0,1] op_sel_hi:[1,1]
    v_pk_mul_f32 v[188:189], v[188:189], v[174:175] op_sel:[0,0] op_sel_hi:[1,0]
    v_pk_mul_f32 v[238:239], v[190:191], v[174:175] op_sel:[0,1] op_sel_hi:[1,1]
    v_pk_mul_f32 v[190:191], v[190:191], v[174:175] op_sel:[0,0] op_sel_hi:[1,0]
    v_pk_fma_f32 v[188:189], v[192:193], v[174:175], v[188:189] op_sel:[0,1,0] op_sel_hi:[1,1,1] neg_lo:[0,1,0] neg_hi:[0,1,0]
    v_pk_fma_f32 v[192:193], v[192:193], v[174:175], v[236:237] op_sel:[0,0,0] op_sel_hi:[1,0,1]
    v_pk_fma_f32 v[190:191], v[194:195], v[174:175], v[190:191] op_sel:[0,1,0] op_sel_hi:[1,1,1] neg_lo:[0,1,0] neg_hi:[0,1,0]
    v_pk_fma_f32 v[194:195], v[194:195], v[174:175], v[238:239] op_sel:[0,0,0] op_sel_hi:[1,0,1]
    v_pk_mul_f32 v[236:237], v[100:101], v[214:215] op_sel:[0,1] op_sel_hi:[1,1]
    v_pk_mul_f32 v[100:101], v[100:101], v[214:215] op_sel:[0,0] op_sel_hi:[1,0]
    v_pk_mul_f32 v[238:239], v[102:103], v[214:215] op_sel:[0,1] op_sel_hi:[1,1]
    v_pk_mul_f32 v[102:103], v[102:103], v[214:215] op_sel:[0,0] op_sel_hi:[1,0]
    v_pk_fma_f32 v[100:101], v[104:105], v[214:215], v[100:101] op_sel:[0,1,0] op_sel_hi:[1,1,1] neg_lo:[0,1,0] neg_hi:[0,1,0]
    v_pk_fma_f32 v[104:105], v[104:105], v[214:215], v[236:237] op_sel:[0,0,0] op_sel_hi:[1,0,1]
    v_pk_fma_f32 v[102:103], v[106:107], v[214:215], v[102:103] op_sel:[0,1,0] op_sel_hi:[1,1,1] neg_lo:[0,1,0] neg_hi:[0,1,0]
    v_pk_fma_f32 v[106:107], v[106:107], v[214:215], v[238:239] op_sel:[0,0,0] op_sel_hi:[1,0,1]
    v_pk_mul_f32 v[236:237], v[132:133], v[214:215] op_sel:[0,1] op_sel_hi:[1,1]
    v_pk_mul_f32 v[132:133], v[132:133], v[214:215] op_sel:[0,0] op_sel_hi:[1,0]
    v_pk_mul_f32 v[238:239], v[134:135], v[214:215] op_sel:[0,1] op_sel_hi:[1,1]
    v_pk_mul_f32 v[134:135], v[134:135], v[214:215] op_sel:[0,0] op_sel_hi:[1,0]
    v_pk_fma_f32 v[132:133], v[136:137], v[214:215], v[132:133] op_sel:[0,1,0] op_sel_hi:[1,1,1] neg_lo:[0,1,0] neg_hi:[0,1,0]
    v_pk_fma_f32 v[136:137], v[136:137], v[214:215], v[236:237] op_sel:[0,0,0] op_sel_hi:[1,0,1]
    v_pk_fma_f32 v[134:135], v[138:139], v[214:215], v[134:135] op_sel:[0,1,0] op_sel_hi:[1,1,1] neg_lo:[0,1,0] neg_hi:[0,1,0]
    v_pk_fma_f32 v[138:139], v[138:139], v[214:215], v[238:239] op_sel:[0,0,0] op_sel_hi:[1,0,1]
    v_pk_mul_f32 v[236:237], v[164:165], v[214:215] op_sel:[0,1] op_sel_hi:[1,1]
    v_pk_mul_f32 v[164:165], v[164:165], v[214:215] op_sel:[0,0] op_sel_hi:[1,0]
    v_pk_mul_f32 v[238:239], v[166:167], v[214:215] op_sel:[0,1] op_sel_hi:[1,1]
    v_pk_mul_f32 v[166:167], v[166:167], v[214:215] op_sel:[0,0] op_sel_hi:[1,0]
    v_pk_fma_f32 v[164:165], v[168:169], v[214:215], v[164:165] op_sel:[0,1,0] op_sel_hi:[1,1,1] neg_lo:[0,1,0] neg_hi:[0,1,0]
    v_pk_fma_f32 v[168:169], v[168:169], v[214:215], v[236:237] op_sel:[0,0,0] op_sel_hi:[1,0,1]
    v_pk_fma_f32 v[166:167], v[170:171], v[214:215], v[166:167] op_sel:[0,1,0] op_sel_hi:[1,1,1] neg_lo:[0,1,0] neg_hi:[0,1,0]
    v_pk_fma_f32 v[170:171], v[170:171], v[214:215], v[238:239] op_sel:[0,0,0] op_sel_hi:[1,0,1]
    v_pk_mul_f32 v[236:237], v[196:197], v[214:215] op_sel:[0,1] op_sel_hi:[1,1]
    v_pk_mul_f32 v[196:197], v[196:197], v[214:215] op_sel:[0,0] op_sel_hi:[1,0]
    v_pk_mul_f32 v[238:239], v[198:199], v[214:215] op_sel:[0,1] op_sel_hi:[1,1]
    v_pk_mul_f32 v[198:199], v[198:199], v[214:215] op_sel:[0,0] op_sel_hi:[1,0]
    v_pk_fma_f32 v[196:197], v[200:201], v[214:215], v[196:197] op_sel:[0,1,0] op_sel_hi:[1,1,1] neg_lo:[0,1,0] neg_hi:[0,1,0]
    v_pk_fma_f32 v[200:201], v[200:201], v[214:215], v[236:237] op_sel:[0,0,0] op_sel_hi:[1,0,1]
    v_pk_fma_f32 v[198:199], v[202:203], v[214:215], v[198:199] op_sel:[0,1,0] op_sel_hi:[1,1,1] neg_lo:[0,1,0] neg_hi:[0,1,0]
    v_pk_fma_f32 v[202:203], v[202:203], v[214:215], v[238:239] op_sel:[0,0,0] op_sel_hi:[1,0,1]
    s_lshl_b32 s31, s20, 1
    s_lshr_b32 s69, s3, 1
    s_add_u32 s31, s31, s69
    s_lshl_b32 s31, s31, 8
    s_lshl_b32 s69, s21, 4
    s_add_u32 s31, s31, s69
    s_and_b32 s69, s3, 1
    s_lshl_b32 s69, s69, 3
    s_add_u32 s31, s31, s69
    s_add_u32 s35, s31, 8192
    v_mov_b32 v2, 0
    v_mov_b32 v4, s72
    v_mov_b32 v5, s73
    s_barrier
    ds_read_b64 v[44:45], v234 offset:0
    ds_read_b64 v[46:47], v234 offset:128
    ds_read_b64 v[48:49], v234 offset:256
    s_waitcnt lgkmcnt(0)
    v_fma_f32 v228, v44, v146, v228
    v_fma_f32 v229, v45, v146, v229
    v_fma_f32 v230, v46, v210, v230
    v_fma_f32 v231, v47, v210, v231
    v_fma_f32 v232, v48, v226, v232
    v_fma_f32 v233, v49, v226, v233
    v_fma_f32 v228, -v45, v147, v228
    v_fma_f32 v229, v44, v147, v229
    v_fma_f32 v230, -v47, v211, v230
    v_fma_f32 v231, v46, v211, v231
    v_fma_f32 v232, -v49, v227, v232
    v_fma_f32 v233, v48, v227, v233
    v_fma_f32 v24, v228, v112, v24
    v_fma_f32 v26, v229, v112, v26
    v_fma_f32 v32, v230, v176, v32
    v_fma_f32 v34, v231, v176, v34
    v_fma_f32 v40, v232, v216, v40
    v_fma_f32 v42, v233, v216, v42
    v_fma_f32 v24, -v229, v113, v24
    v_fma_f32 v26, v228, v113, v26
    v_fma_f32 v32, -v231, v177, v32
    v_fma_f32 v34, v230, v177, v34
    v_fma_f32 v40, -v233, v217, v40
    v_fma_f32 v42, v232, v217, v42
    v_mul_f32 v240, v228, v110
    v_mul_f32 v242, v229, v110
    v_mul_f32 v241, v24, v110
    v_mul_f32 v243, v26, v110
    v_mul_f32 v244, v230, v174
    v_mul_f32 v246, v231, v174
    v_mul_f32 v245, v32, v174
    v_mul_f32 v247, v34, v174
    v_mul_f32 v248, v232, v214
    v_mul_f32 v250, v233, v214
    v_mul_f32 v249, v40, v214
    v_mul_f32_e64 v251, v42, v214
    v_fma_f32 v240, -v229, v111, v240
    v_fma_f32 v242, v228, v111, v242
    v_fma_f32 v241, -v26, v111, v241
    v_fma_f32 v243, v24, v111, v243
    v_fma_f32 v244, -v231, v175, v244
    v_fma_f32 v246, v230, v175, v246
    v_fma_f32 v245, -v34, v175, v245
    v_fma_f32 v247, v32, v175, v247
    v_fma_f32 v248, -v233, v215, v248
    v_fma_f32 v250, v232, v215, v250
    v_fma_f32 v249, -v42, v215, v249
    v_fma_f32 v251, v40, v215, v251
    v_pk_fma_f32 v[84:85], v[240:241], v[108:109], v[84:85] op_sel:[0,0,0] op_sel_hi:[1,0,1]
    v_pk_fma_f32 v[88:89], v[242:243], v[108:109], v[88:89] op_sel:[0,0,0] op_sel_hi:[1,0,1]
    v_pk_fma_f32 v[92:93], v[244:245], v[172:173], v[92:93] op_sel:[0,0,0] op_sel_hi:[1,0,1]
    v_pk_fma_f32 v[96:97], v[246:247], v[172:173], v[96:97] op_sel:[0,0,0] op_sel_hi:[1,0,1]
    v_pk_fma_f32 v[100:101], v[248:249], v[212:213], v[100:101] op_sel:[0,0,0] op_sel_hi:[1,0,1]
    v_pk_fma_f32 v[104:105], v[250:251], v[212:213], v[104:105] op_sel:[0,0,0] op_sel_hi:[1,0,1]
    v_pk_fma_f32 v[84:85], v[242:243], v[108:109], v[84:85] op_sel:[0,1,0] op_sel_hi:[1,1,1] neg_lo:[0,1,0] neg_hi:[0,1,0]
    v_pk_fma_f32 v[88:89], v[240:241], v[108:109], v[88:89] op_sel:[0,1,0] op_sel_hi:[1,1,1]
    v_pk_fma_f32 v[92:93], v[246:247], v[172:173], v[92:93] op_sel:[0,1,0] op_sel_hi:[1,1,1] neg_lo:[0,1,0] neg_hi:[0,1,0]
    v_pk_fma_f32 v[96:97], v[244:245], v[172:173], v[96:97] op_sel:[0,1,0] op_sel_hi:[1,1,1]
    v_pk_fma_f32 v[100:101], v[250:251], v[212:213], v[100:101] op_sel:[0,1,0] op_sel_hi:[1,1,1] neg_lo:[0,1,0] neg_hi:[0,1,0]
    v_pk_fma_f32 v[104:105], v[248:249], v[212:213], v[104:105] op_sel:[0,1,0] op_sel_hi:[1,1,1]
    v_pk_fma_f32 v[86:87], v[84:85], v[108:109], v[86:87] op_sel:[0,0,0] op_sel_hi:[1,0,1]
    v_pk_fma_f32 v[90:91], v[88:89], v[108:109], v[90:91] op_sel:[0,0,0] op_sel_hi:[1,0,1]
    v_pk_fma_f32 v[94:95], v[92:93], v[172:173], v[94:95] op_sel:[0,0,0] op_sel_hi:[1,0,1]
    v_pk_fma_f32 v[98:99], v[96:97], v[172:173], v[98:99] op_sel:[0,0,0] op_sel_hi:[1,0,1]
    v_pk_fma_f32 v[102:103], v[100:101], v[212:213], v[102:103] op_sel:[0,0,0] op_sel_hi:[1,0,1]
    v_pk_fma_f32 v[106:107], v[104:105], v[212:213], v[106:107] op_sel:[0,0,0] op_sel_hi:[1,0,1]
    v_pk_fma_f32 v[86:87], v[88:89], v[108:109], v[86:87] op_sel:[0,1,0] op_sel_hi:[1,1,1] neg_lo:[0,1,0] neg_hi:[0,1,0]
    v_pk_fma_f32 v[90:91], v[84:85], v[108:109], v[90:91] op_sel:[0,1,0] op_sel_hi:[1,1,1]
    v_pk_fma_f32 v[94:95], v[96:97], v[172:173], v[94:95] op_sel:[0,1,0] op_sel_hi:[1,1,1] neg_lo:[0,1,0] neg_hi:[0,1,0]
    v_pk_fma_f32 v[98:99], v[92:93], v[172:173], v[98:99] op_sel:[0,1,0] op_sel_hi:[1,1,1]
    v_pk_fma_f32 v[102:103], v[104:105], v[212:213], v[102:103] op_sel:[0,1,0] op_sel_hi:[1,1,1] neg_lo:[0,1,0] neg_hi:[0,1,0]
    v_pk_fma_f32 v[106:107], v[100:101], v[212:213], v[106:107] op_sel:[0,1,0] op_sel_hi:[1,1,1]
    v_pk_fma_f32 v[116:117], v[86:87], v[108:109], v[116:117] op_sel:[0,0,0] op_sel_hi:[1,0,1]
    v_pk_fma_f32 v[120:121], v[90:91], v[108:109], v[120:121] op_sel:[0,0,0] op_sel_hi:[1,0,1]
    v_pk_fma_f32 v[124:125], v[94:95], v[172:173], v[124:125] op_sel:[0,0,0] op_sel_hi:[1,0,1]
    v_pk_fma_f32 v[128:129], v[98:99], v[172:173], v[128:129] op_sel:[0,0,0] op_sel_hi:[1,0,1]
    v_pk_fma_f32 v[132:133], v[102:103], v[212:213], v[132:133] op_sel:[0,0,0] op_sel_hi:[1,0,1]
    v_pk_fma_f32 v[136:137], v[106:107], v[212:213], v[136:137] op_sel:[0,0,0] op_sel_hi:[1,0,1]
    v_pk_fma_f32 v[116:117], v[90:91], v[108:109], v[116:117] op_sel:[0,1,0] op_sel_hi:[1,1,1] neg_lo:[0,1,0] neg_hi:[0,1,0]
    v_pk_fma_f32 v[120:121], v[86:87], v[108:109], v[120:121] op_sel:[0,1,0] op_sel_hi:[1,1,1]
    v_pk_fma_f32 v[124:125], v[98:99], v[172:173], v[124:125] op_sel:[0,1,0] op_sel_hi:[1,1,1] neg_lo:[0,1,0] neg_hi:[0,1,0]
    v_pk_fma_f32 v[128:129], v[94:95], v[172:173], v[128:129] op_sel:[0,1,0] op_sel_hi:[1,1,1]
    v_pk_fma_f32 v[132:133], v[106:107], v[212:213], v[132:133] op_sel:[0,1,0] op_sel_hi:[1,1,1] neg_lo:[0,1,0] neg_hi:[0,1,0]
    v_pk_fma_f32 v[136:137], v[102:103], v[212:213], v[136:137] op_sel:[0,1,0] op_sel_hi:[1,1,1]
    v_pk_fma_f32 v[118:119], v[116:117], v[108:109], v[118:119] op_sel:[0,0,0] op_sel_hi:[1,0,1]
    v_pk_fma_f32 v[122:123], v[120:121], v[108:109], v[122:123] op_sel:[0,0,0] op_sel_hi:[1,0,1]
    v_pk_fma_f32 v[126:127], v[124:125], v[172:173], v[126:127] op_sel:[0,0,0] op_sel_hi:[1,0,1]
    v_pk_fma_f32 v[130:131], v[128:129], v[172:173], v[130:131] op_sel:[0,0,0] op_sel_hi:[1,0,1]
    v_pk_fma_f32 v[134:135], v[132:133], v[212:213], v[134:135] op_sel:[0,0,0] op_sel_hi:[1,0,1]
    v_pk_fma_f32 v[138:139], v[136:137], v[212:213], v[138:139] op_sel:[0,0,0] op_sel_hi:[1,0,1]
    v_pk_fma_f32 v[118:119], v[120:121], v[108:109], v[118:119] op_sel:[0,1,0] op_sel_hi:[1,1,1] neg_lo:[0,1,0] neg_hi:[0,1,0]
    v_pk_fma_f32 v[122:123], v[116:117], v[108:109], v[122:123] op_sel:[0,1,0] op_sel_hi:[1,1,1]
    v_pk_fma_f32 v[126:127], v[128:129], v[172:173], v[126:127] op_sel:[0,1,0] op_sel_hi:[1,1,1] neg_lo:[0,1,0] neg_hi:[0,1,0]
    v_pk_fma_f32 v[130:131], v[124:125], v[172:173], v[130:131] op_sel:[0,1,0] op_sel_hi:[1,1,1]
    v_pk_fma_f32 v[134:135], v[136:137], v[212:213], v[134:135] op_sel:[0,1,0] op_sel_hi:[1,1,1] neg_lo:[0,1,0] neg_hi:[0,1,0]
    v_pk_fma_f32 v[138:139], v[132:133], v[212:213], v[138:139] op_sel:[0,1,0] op_sel_hi:[1,1,1]
    v_pk_fma_f32 v[148:149], v[118:119], v[108:109], v[148:149] op_sel:[0,0,0] op_sel_hi:[1,0,1]
    v_pk_fma_f32 v[152:153], v[122:123], v[108:109], v[152:153] op_sel:[0,0,0] op_sel_hi:[1,0,1]
    v_pk_fma_f32 v[156:157], v[126:127], v[172:173], v[156:157] op_sel:[0,0,0] op_sel_hi:[1,0,1]
    v_pk_fma_f32 v[160:161], v[130:131], v[172:173], v[160:161] op_sel:[0,0,0] op_sel_hi:[1,0,1]
    v_pk_fma_f32 v[164:165], v[134:135], v[212:213], v[164:165] op_sel:[0,0,0] op_sel_hi:[1,0,1]
    v_pk_fma_f32 v[168:169], v[138:139], v[212:213], v[168:169] op_sel:[0,0,0] op_sel_hi:[1,0,1]
    v_pk_fma_f32 v[148:149], v[122:123], v[108:109], v[148:149] op_sel:[0,1,0] op_sel_hi:[1,1,1] neg_lo:[0,1,0] neg_hi:[0,1,0]
    v_pk_fma_f32 v[152:153], v[118:119], v[108:109], v[152:153] op_sel:[0,1,0] op_sel_hi:[1,1,1]
    v_pk_fma_f32 v[156:157], v[130:131], v[172:173], v[156:157] op_sel:[0,1,0] op_sel_hi:[1,1,1] neg_lo:[0,1,0] neg_hi:[0,1,0]
    v_pk_fma_f32 v[160:161], v[126:127], v[172:173], v[160:161] op_sel:[0,1,0] op_sel_hi:[1,1,1]
    v_pk_fma_f32 v[164:165], v[138:139], v[212:213], v[164:165] op_sel:[0,1,0] op_sel_hi:[1,1,1] neg_lo:[0,1,0] neg_hi:[0,1,0]
    v_pk_fma_f32 v[168:169], v[134:135], v[212:213], v[168:169] op_sel:[0,1,0] op_sel_hi:[1,1,1]
    v_pk_fma_f32 v[150:151], v[148:149], v[108:109], v[150:151] op_sel:[0,0,0] op_sel_hi:[1,0,1]
    v_pk_fma_f32 v[154:155], v[152:153], v[108:109], v[154:155] op_sel:[0,0,0] op_sel_hi:[1,0,1]
    v_pk_fma_f32 v[158:159], v[156:157], v[172:173], v[158:159] op_sel:[0,0,0] op_sel_hi:[1,0,1]
    v_pk_fma_f32 v[162:163], v[160:161], v[172:173], v[162:163] op_sel:[0,0,0] op_sel_hi:[1,0,1]
    v_pk_fma_f32 v[166:167], v[164:165], v[212:213], v[166:167] op_sel:[0,0,0] op_sel_hi:[1,0,1]
    v_pk_fma_f32 v[170:171], v[168:169], v[212:213], v[170:171] op_sel:[0,0,0] op_sel_hi:[1,0,1]
    v_pk_fma_f32 v[150:151], v[152:153], v[108:109], v[150:151] op_sel:[0,1,0] op_sel_hi:[1,1,1] neg_lo:[0,1,0] neg_hi:[0,1,0]
    v_pk_fma_f32 v[154:155], v[148:149], v[108:109], v[154:155] op_sel:[0,1,0] op_sel_hi:[1,1,1]
    v_pk_fma_f32 v[158:159], v[160:161], v[172:173], v[158:159] op_sel:[0,1,0] op_sel_hi:[1,1,1] neg_lo:[0,1,0] neg_hi:[0,1,0]
    v_pk_fma_f32 v[162:163], v[156:157], v[172:173], v[162:163] op_sel:[0,1,0] op_sel_hi:[1,1,1]
    v_pk_fma_f32 v[166:167], v[168:169], v[212:213], v[166:167] op_sel:[0,1,0] op_sel_hi:[1,1,1] neg_lo:[0,1,0] neg_hi:[0,1,0]
    v_pk_fma_f32 v[170:171], v[164:165], v[212:213], v[170:171] op_sel:[0,1,0] op_sel_hi:[1,1,1]
    v_pk_fma_f32 v[180:181], v[150:151], v[108:109], v[180:181] op_sel:[0,0,0] op_sel_hi:[1,0,1]
    v_pk_fma_f32 v[184:185], v[154:155], v[108:109], v[184:185] op_sel:[0,0,0] op_sel_hi:[1,0,1]
    v_pk_fma_f32 v[188:189], v[158:159], v[172:173], v[188:189] op_sel:[0,0,0] op_sel_hi:[1,0,1]
    v_pk_fma_f32 v[192:193], v[162:163], v[172:173], v[192:193] op_sel:[0,0,0] op_sel_hi:[1,0,1]
    v_pk_fma_f32 v[196:197], v[166:167], v[212:213], v[196:197] op_sel:[0,0,0] op_sel_hi:[1,0,1]
    v_pk_fma_f32 v[200:201], v[170:171], v[212:213], v[200:201] op_sel:[0,0,0] op_sel_hi:[1,0,1]
    v_pk_fma_f32 v[180:181], v[154:155], v[108:109], v[180:181] op_sel:[0,1,0] op_sel_hi:[1,1,1] neg_lo:[0,1,0] neg_hi:[0,1,0]
    v_pk_fma_f32 v[184:185], v[150:151], v[108:109], v[184:185] op_sel:[0,1,0] op_sel_hi:[1,1,1]
    v_pk_fma_f32 v[188:189], v[162:163], v[172:173], v[188:189] op_sel:[0,1,0] op_sel_hi:[1,1,1] neg_lo:[0,1,0] neg_hi:[0,1,0]
    v_pk_fma_f32 v[192:193], v[158:159], v[172:173], v[192:193] op_sel:[0,1,0] op_sel_hi:[1,1,1]
    v_pk_fma_f32 v[196:197], v[170:171], v[212:213], v[196:197] op_sel:[0,1,0] op_sel_hi:[1,1,1] neg_lo:[0,1,0] neg_hi:[0,1,0]
    v_pk_fma_f32 v[200:201], v[166:167], v[212:213], v[200:201] op_sel:[0,1,0] op_sel_hi:[1,1,1]
    v_pk_fma_f32 v[182:183], v[180:181], v[108:109], v[182:183] op_sel:[0,0,0] op_sel_hi:[1,0,1]
    v_pk_fma_f32 v[186:187], v[184:185], v[108:109], v[186:187] op_sel:[0,0,0] op_sel_hi:[1,0,1]
    v_pk_fma_f32 v[190:191], v[188:189], v[172:173], v[190:191] op_sel:[0,0,0] op_sel_hi:[1,0,1]
    v_pk_fma_f32 v[194:195], v[192:193], v[172:173], v[194:195] op_sel:[0,0,0] op_sel_hi:[1,0,1]
    v_pk_fma_f32 v[198:199], v[196:197], v[212:213], v[198:199] op_sel:[0,0,0] op_sel_hi:[1,0,1]
    v_pk_fma_f32 v[202:203], v[200:201], v[212:213], v[202:203] op_sel:[0,0,0] op_sel_hi:[1,0,1]
    v_pk_fma_f32 v[182:183], v[184:185], v[108:109], v[182:183] op_sel:[0,1,0] op_sel_hi:[1,1,1] neg_lo:[0,1,0] neg_hi:[0,1,0]
    v_pk_fma_f32 v[186:187], v[180:181], v[108:109], v[186:187] op_sel:[0,1,0] op_sel_hi:[1,1,1]
    v_pk_fma_f32 v[190:191], v[192:193], v[172:173], v[190:191] op_sel:[0,1,0] op_sel_hi:[1,1,1] neg_lo:[0,1,0] neg_hi:[0,1,0]
    v_pk_fma_f32 v[194:195], v[188:189], v[172:173], v[194:195] op_sel:[0,1,0] op_sel_hi:[1,1,1]
    v_pk_fma_f32 v[198:199], v[200:201], v[212:213], v[198:199] op_sel:[0,1,0] op_sel_hi:[1,1,1] neg_lo:[0,1,0] neg_hi:[0,1,0]
    v_pk_fma_f32 v[202:203], v[196:197], v[212:213], v[202:203] op_sel:[0,1,0] op_sel_hi:[1,1,1]
    v_cvt_pk_bf16_f32 v20, v84, v86
    v_cvt_pk_bf16_f32 v21, v116, v118
    v_cvt_pk_bf16_f32 v22, v148, v150
    v_cvt_pk_bf16_f32 v23, v180, v182
    ds_write_b128 v7, v[20:23] offset:0
    v_cvt_pk_bf16_f32 v24, v85, v87
    v_cvt_pk_bf16_f32 v25, v117, v119
    v_cvt_pk_bf16_f32 v26, v149, v151
    v_cvt_pk_bf16_f32 v27, v181, v183
    ds_write_b128 v7, v[24:27] offset:16
    v_cvt_pk_bf16_f32 v28, -v88, -v90
    v_cvt_pk_bf16_f32 v29, -v120, -v122
    v_cvt_pk_bf16_f32 v30, -v152, -v154
    v_cvt_pk_bf16_f32 v31, -v184, -v186
    ds_write_b128 v7, v[28:31] offset:5760
    v_cvt_pk_bf16_f32 v32, -v89, -v91
    v_cvt_pk_bf16_f32 v33, -v121, -v123
    v_cvt_pk_bf16_f32 v34, -v153, -v155
    v_cvt_pk_bf16_f32 v35, -v185, -v187
    ds_write_b128 v7, v[32:35] offset:5776
    v_cvt_pk_bf16_f32 v36, v92, v94
    v_cvt_pk_bf16_f32 v37, v124, v126
    v_cvt_pk_bf16_f32 v38, v156, v158
    v_cvt_pk_bf16_f32 v39, v188, v190
    ds_write_b128 v7, v[36:39] offset:2304
    v_cvt_pk_bf16_f32 v40, v93, v95
    v_cvt_pk_bf16_f32 v41, v125, v127
    v_cvt_pk_bf16_f32 v42, v157, v159
    v_cvt_pk_bf16_f32 v43, v189, v191
    ds_write_b128 v7, v[40:43] offset:2320
    v_cvt_pk_bf16_f32 v20, -v96, -v98
    v_cvt_pk_bf16_f32 v21, -v128, -v130
    v_cvt_pk_bf16_f32 v22, -v160, -v162
    v_cvt_pk_bf16_f32 v23, -v192, -v194
    ds_write_b128 v7, v[20:23] offset:8064
    v_cvt_pk_bf16_f32 v24, -v97, -v99
    v_cvt_pk_bf16_f32 v25, -v129, -v131
    v_cvt_pk_bf16_f32 v26, -v161, -v163
    v_cvt_pk_bf16_f32 v27, -v193, -v195
    ds_write_b128 v7, v[24:27] offset:8080
    v_cvt_pk_bf16_f32 v28, v100, v102
    v_cvt_pk_bf16_f32 v29, v132, v134
    v_cvt_pk_bf16_f32 v30, v164, v166
    v_cvt_pk_bf16_f32 v31, v196, v198
    v_xor_b32 v28, v28, v19
    v_xor_b32 v29, v29, v19
    v_xor_b32 v30, v30, v19
    v_xor_b32 v31, v31, v19
    ds_write_b128 v14, v[28:31] offset:0
    v_cvt_pk_bf16_f32 v32, v101, v103
    v_cvt_pk_bf16_f32 v33, v133, v135
    v_cvt_pk_bf16_f32 v34, v165, v167
    v_cvt_pk_bf16_f32 v35, v197, v199
    v_xor_b32 v32, v32, v19
    v_xor_b32 v33, v33, v19
    v_xor_b32 v34, v34, v19
    v_xor_b32 v35, v35, v19
    ds_write_b128 v14, v[32:35] offset:16
    ds_read_b64_tr_b16 v[44:45], v15 offset:0
    ds_read_b64_tr_b16 v[46:47], v15 offset:576
    ds_read_b64_tr_b16 v[48:49], v15 offset:1152
    ds_read_b64_tr_b16 v[50:51], v15 offset:1728
    ds_read_b64_tr_b16 v[52:53], v15 offset:2304
    ds_read_b64_tr_b16 v[54:55], v15 offset:2880
    ds_read_b64_tr_b16 v[56:57], v15 offset:3456
    ds_read_b64_tr_b16 v[58:59], v15 offset:4032
    ds_read_b64_tr_b16 v[60:61], v15 offset:4608
    ds_read_b64_tr_b16 v[62:63], v15 offset:5184
    ds_read_b64_tr_b16 v[64:65], v15 offset:5760
    ds_read_b64_tr_b16 v[66:67], v15 offset:6336
    ds_read_b64_tr_b16 v[68:69], v15 offset:6912
    ds_read_b64_tr_b16 v[70:71], v15 offset:7488
    ds_read_b64_tr_b16 v[72:73], v15 offset:8064
    ds_read_b64_tr_b16 v[74:75], v15 offset:8640
    ds_read_b64_tr_b16 v[76:77], v15 offset:9216
    ds_read_b64_tr_b16 v[78:79], v15 offset:9792
    ds_read_b64_tr_b16 v[80:81], v15 offset:10368
    ds_read_b64_tr_b16 v[82:83], v15 offset:10944
    s_waitcnt lgkmcnt(15)
    buffer_store_dwordx4 v[44:47], v18, s[12:15], s32 offen offset:0 sc1
    s_waitcnt lgkmcnt(15)
    buffer_store_dwordx4 v[48:51], v18, s[12:15], s32 offen offset:256 sc1
    s_waitcnt lgkmcnt(14)
    buffer_store_dwordx4 v[52:55], v18, s[12:15], s32 offen offset:512 sc1
    s_waitcnt lgkmcnt(12)
    buffer_store_dwordx4 v[56:59], v18, s[12:15], s32 offen offset:768 sc1
    s_waitcnt lgkmcnt(10)
    buffer_store_dwordx4 v[60:63], v18, s[12:15], s32 offen offset:1024 sc1
    s_waitcnt lgkmcnt(8)
    buffer_store_dwordx4 v[64:67], v18, s[12:15], s33 offen offset:0 sc1
    s_waitcnt lgkmcnt(6)
    buffer_store_dwordx4 v[68:71], v18, s[12:15], s33 offen offset:256 sc1
    s_waitcnt lgkmcnt(4)
    buffer_store_dwordx4 v[72:75], v18, s[12:15], s33 offen offset:512 sc1
    s_waitcnt lgkmcnt(2)
    buffer_store_dwordx4 v[76:79], v18, s[12:15], s33 offen offset:768 sc1
    s_waitcnt lgkmcnt(0)
    buffer_store_dwordx4 v[80:83], v18, s[12:15], s33 offen offset:1024 sc1
    s_mov_b64 exec, 1
    s_waitcnt vmcnt(0)
    buffer_store_dwordx2 v[4:5], v2, s[12:15], s35 offen sc1
    s_mov_b64 exec, -1
    s_barrier
    s_branch L_B_phase2
L_B_helper:
    v_and_b32 v22, 7, v1
    v_xor_b32 v22, v22, v17
    v_lshrrev_b32 v23, 3, v1
    v_mul_u32_u24 v23, 1280, v23
    v_lshl_add_u32 v20, v22, 4, v23
    v_xor_b32_e64 v22, 4, v22
    v_lshl_add_u32 v21, v22, 4, v23
    s_lshr_b32 s26, s30, 2
    s_mul_i32 s26, s26, 102400
    s_mov_b32 s10, 819200
    v_lshlrev_b32 v2, 4, v1
    v_cmp_gt_u32 vcc, 48, v1
    v_mov_b32 v3, 1073741824
    s_mov_b64 s[74:75], vcc
    v_cndmask_b32 v2, v3, v2, vcc
    v_lshlrev_b32_e64 v3, 3, v1
    v_add_u32 v3, 156160, v3
    s_lshl_b32 s31, s21, 3
    s_mul_i32 s31, s31, 768
    s_add_u32 s31, s31, 16384
    s_mov_b32 s79, 0
    s_lshl_b32 s76, -1, s20
    s_and_b32 s76, s76, 127
    s_barrier
    s_cmp_eq_u32 s67, 0
    s_cbranch_scc1 L_Bh_poll
    s_cmp_eq_u32 s67, 1
    s_cbranch_scc1 L_Bh_done
    s_sub_u32 s31, s67, 2
    s_cmp_eq_u32 s31, 0
    s_cselect_b32 s8, s50, s52
    s_cselect_b32 s9, s51, s53
    s_mul_i32 s25, s31, 10240
    s_add_u32 m0, s25, 0
    s_add_u32 s23, s26, 0
    buffer_load_dwordx4 v20, s[8:11], s23 offen lds
    s_add_u32 m0, s25, 1024
    s_add_u32 s23, s26, 10240
    buffer_load_dwordx4 v21, s[8:11], s23 offen lds
    s_add_u32 m0, s25, 2048
    s_add_u32 s23, s26, 20480
    buffer_load_dwordx4 v20, s[8:11], s23 offen lds
    s_add_u32 m0, s25, 3072
    s_add_u32 s23, s26, 30720
    buffer_load_dwordx4 v21, s[8:11], s23 offen lds
    s_add_u32 m0, s25, 4096
    s_add_u32 s23, s26, 40960
    buffer_load_dwordx4 v20, s[8:11], s23 offen lds
    s_add_u32 m0, s25, 5120
    s_add_u32 s23, s26, 51200
    buffer_load_dwordx4 v21, s[8:11], s23 offen lds
    s_add_u32 m0, s25, 6144
    s_add_u32 s23, s26, 61440
    buffer_load_dwordx4 v20, s[8:11], s23 offen lds
    s_add_u32 m0, s25, 7168
    s_add_u32 s23, s26, 71680
    buffer_load_dwordx4 v21, s[8:11], s23 offen lds
    s_add_u32 m0, s25, 8192
    s_add_u32 s23, s26, 81920
    buffer_load_dwordx4 v20, s[8:11], s23 offen lds
    s_add_u32 m0, s25, 9216
    s_add_u32 s23, s26, 92160
    buffer_load_dwordx4 v21, s[8:11], s23 offen lds
    s_add_u32 m0, s25, 20480
    s_add_u32 s23, s26, 128
    buffer_load_dwordx4 v20, s[8:11], s23 offen lds
    s_add_u32 m0, s25, 21504
    s_add_u32 s23, s26, 10368
    buffer_load_dwordx4 v21, s[8:11], s23 offen lds
    s_add_u32 m0, s25, 22528
    s_add_u32 s23, s26, 20608
    buffer_load_dwordx4 v20, s[8:11], s23 offen lds
    s_add_u32 m0, s25, 23552
    s_add_u32 s23, s26, 30848
    buffer_load_dwordx4 v21, s[8:11], s23 offen lds
    s_add_u32 m0, s25, 24576
    s_add_u32 s23, s26, 41088
    buffer_load_dwordx4 v20, s[8:11], s23 offen lds
    s_add_u32 m0, s25, 25600
    s_add_u32 s23, s26, 51328
    buffer_load_dwordx4 v21, s[8:11], s23 offen lds
    s_add_u32 m0, s25, 26624
    s_add_u32 s23, s26, 61568
    buffer_load_dwordx4 v20, s[8:11], s23 offen lds
    s_add_u32 m0, s25, 27648
    s_add_u32 s23, s26, 71808
    buffer_load_dwordx4 v21, s[8:11], s23 offen lds
    s_add_u32 m0, s25, 28672
    s_add_u32 s23, s26, 82048
    buffer_load_dwordx4 v20, s[8:11], s23 offen lds
    s_add_u32 m0, s25, 29696
    s_add_u32 s23, s26, 92288
    buffer_load_dwordx4 v21, s[8:11], s23 offen lds
    s_add_u32 m0, s25, 40960
    s_add_u32 s23, s26, 256
    buffer_load_dwordx4 v20, s[8:11], s23 offen lds
    s_add_u32 m0, s25, 41984
    s_add_u32 s23, s26, 10496
    buffer_load_dwordx4 v21, s[8:11], s23 offen lds
    s_add_u32 m0, s25, 43008
    s_add_u32 s23, s26, 20736
    buffer_load_dwordx4 v20, s[8:11], s23 offen lds
    s_add_u32 m0, s25, 44032
    s_add_u32 s23, s26, 30976
    buffer_load_dwordx4 v21, s[8:11], s23 offen lds
    s_add_u32 m0, s25, 45056
    s_add_u32 s23, s26, 41216
    buffer_load_dwordx4 v20, s[8:11], s23 offen lds
    s_add_u32 m0, s25, 46080
    s_add_u32 s23, s26, 51456
    buffer_load_dwordx4 v21, s[8:11], s23 offen lds
    s_add_u32 m0, s25, 47104
    s_add_u32 s23, s26, 61696
    buffer_load_dwordx4 v20, s[8:11], s23 offen lds
    s_add_u32 m0, s25, 48128
    s_add_u32 s23, s26, 71936
    buffer_load_dwordx4 v21, s[8:11], s23 offen lds
    s_add_u32 m0, s25, 49152
    s_add_u32 s23, s26, 82176
    buffer_load_dwordx4 v20, s[8:11], s23 offen lds
    s_add_u32 m0, s25, 50176
    s_add_u32 s23, s26, 92416
    buffer_load_dwordx4 v21, s[8:11], s23 offen lds
    s_add_u32 m0, s25, 61440
    s_add_u32 s23, s26, 384
    buffer_load_dwordx4 v20, s[8:11], s23 offen lds
    s_add_u32 m0, s25, 62464
    s_add_u32 s23, s26, 10624
    buffer_load_dwordx4 v21, s[8:11], s23 offen lds
    s_add_u32 m0, s25, 63488
    s_add_u32 s23, s26, 20864
    buffer_load_dwordx4 v20, s[8:11], s23 offen lds
    s_add_u32 m0, s25, 64512
    s_add_u32 s23, s26, 31104
    buffer_load_dwordx4 v21, s[8:11], s23 offen lds
    s_add_u32 m0, s25, 65536
    s_add_u32 s23, s26, 41344
    buffer_load_dwordx4 v20, s[8:11], s23 offen lds
    s_add_u32 m0, s25, 66560
    s_add_u32 s23, s26, 51584
    buffer_load_dwordx4 v21, s[8:11], s23 offen lds
    s_add_u32 m0, s25, 67584
    s_add_u32 s23, s26, 61824
    buffer_load_dwordx4 v20, s[8:11], s23 offen lds
    s_add_u32 m0, s25, 68608
    s_add_u32 s23, s26, 72064
    buffer_load_dwordx4 v21, s[8:11], s23 offen lds
    s_add_u32 m0, s25, 69632
    s_add_u32 s23, s26, 82304
    buffer_load_dwordx4 v20, s[8:11], s23 offen lds
    s_add_u32 m0, s25, 70656
    s_add_u32 s23, s26, 92544
    buffer_load_dwordx4 v21, s[8:11], s23 offen lds
    s_add_u32 m0, s25, 81920
    s_add_u32 s23, s26, 512
    buffer_load_dwordx4 v20, s[8:11], s23 offen lds
    s_add_u32 m0, s25, 82944
    s_add_u32 s23, s26, 10752
    buffer_load_dwordx4 v21, s[8:11], s23 offen lds
    s_add_u32 m0, s25, 83968
    s_add_u32 s23, s26, 20992
    buffer_load_dwordx4 v20, s[8:11], s23 offen lds
    s_add_u32 m0, s25, 84992
    s_add_u32 s23, s26, 31232
    buffer_load_dwordx4 v21, s[8:11], s23 offen lds
    s_add_u32 m0, s25, 86016
    s_add_u32 s23, s26, 41472
    buffer_load_dwordx4 v20, s[8:11], s23 offen lds
    s_add_u32 m0, s25, 87040
    s_add_u32 s23, s26, 51712
    buffer_load_dwordx4 v21, s[8:11], s23 offen lds
    s_add_u32 m0, s25, 88064
    s_add_u32 s23, s26, 61952
    buffer_load_dwordx4 v20, s[8:11], s23 offen lds
    s_add_u32 m0, s25, 89088
    s_add_u32 s23, s26, 72192
    buffer_load_dwordx4 v21, s[8:11], s23 offen lds
    s_add_u32 m0, s25, 90112
    s_add_u32 s23, s26, 82432
    buffer_load_dwordx4 v20, s[8:11], s23 offen lds
    s_add_u32 m0, s25, 91136
    s_add_u32 s23, s26, 92672
    buffer_load_dwordx4 v21, s[8:11], s23 offen lds
    s_barrier
    s_waitcnt vmcnt(0)
    s_branch L_Bh_b3
L_Bh_poll:
    s_bitcmp1_b32 s76, 0
    s_cbranch_scc1 L_g_21
    s_add_u32 s69, s31, 0
    buffer_load_dwordx4 v[40:43], v2, s[12:15], s69 offen sc1
L_g_21:
    s_bitcmp1_b32 s76, 1
    s_cbranch_scc1 L_g_22
    s_add_u32 s69, s31, 768
    buffer_load_dwordx4 v[44:47], v2, s[12:15], s69 offen sc1
L_g_22:
    s_bitcmp1_b32 s76, 2
    s_cbranch_scc1 L_g_23
    s_add_u32 s69, s31, 1536
    buffer_load_dwordx4 v[48:51], v2, s[12:15], s69 offen sc1
L_g_23:
    s_bitcmp1_b32 s76, 3
    s_cbranch_scc1 L_g_24
    s_add_u32 s69, s31, 2304
    buffer_load_dwordx4 v[52:55], v2, s[12:15], s69 offen sc1
L_g_24:
    s_bitcmp1_b32 s76, 4
    s_cbranch_scc1 L_g_25
    s_add_u32 s69, s31, 3072
    buffer_load_dwordx4 v[56:59], v2, s[12:15], s69 offen sc1
L_g_25:
    s_bitcmp1_b32 s76, 5
    s_cbranch_scc1 L_g_26
    s_add_u32 s69, s31, 3840
    buffer_load_dwordx4 v[60:63], v2, s[12:15], s69 offen sc1
L_g_26:
    s_bitcmp1_b32 s76, 6
    s_cbranch_scc1 L_g_27
    s_add_u32 s69, s31, 4608
    buffer_load_dwordx4 v[64:67], v2, s[12:15], s69 offen sc1
L_g_27:
    s_waitcnt vmcnt(0)
    v_cmp_ne_u64 vcc, s[72:73], v[42:43]
    s_and_b64 s[68:69], vcc, s[74:75]
    s_cselect_b32 s77, 0, 1
    s_or_b32 s76, s76, s77
    v_cmp_ne_u64 vcc, s[72:73], v[46:47]
    s_and_b64 s[68:69], vcc, s[74:75]
    s_cselect_b32 s77, 0, 2
    s_or_b32 s76, s76, s77
    v_cmp_ne_u64 vcc, s[72:73], v[50:51]
    s_and_b64 s[68:69], vcc, s[74:75]
    s_cselect_b32 s77, 0, 4
    s_or_b32 s76, s76, s77
    v_cmp_ne_u64 vcc, s[72:73], v[54:55]
    s_and_b64 s[68:69], vcc, s[74:75]
    s_cselect_b32 s77, 0, 8
    s_or_b32 s76, s76, s77
    v_cmp_ne_u64 vcc, s[72:73], v[58:59]
    s_and_b64 s[68:69], vcc, s[74:75]
    s_cselect_b32 s77, 0, 16
    s_or_b32 s76, s76, s77
    v_cmp_ne_u64 vcc, s[72:73], v[62:63]
    s_and_b64 s[68:69], vcc, s[74:75]
    s_cselect_b32 s77, 0, 32
    s_or_b32 s76, s76, s77
    v_cmp_ne_u64 vcc, s[72:73], v[66:67]
    s_and_b64 s[68:69], vcc, s[74:75]
    s_cselect_b32 s77, 0, 64
    s_or_b32 s76, s76, s77
    s_cmp_eq_u32 s76, 127
    s_cbranch_scc1 L_Bh_ok
    s_add_u32 s79, s79, 1
    s_cmp_lt_u32 s79, 0x8000
    s_cbranch_scc1 L_Bh_poll
L_Bh_ok:
    v_mov_b32 v36, 0
    v_mov_b32 v37, 0
    s_cmp_le_u32 s20, 0
    s_cbranch_scc1 L_Bh_w
    v_fma_f32 v40, v36, v30, v40
    v_fma_f32 v41, v37, v30, v41
    v_fma_f32 v38, -v37, v31, v40
    v_fma_f32 v37, v36, v31, v41
    v_mov_b32_e64 v36, v38
    s_cmp_le_u32 s20, 1
    s_cbranch_scc1 L_Bh_w
    v_fma_f32 v44, v36, v30, v44
    v_fma_f32 v45, v37, v30, v45
    v_fma_f32 v38, -v37, v31, v44
    v_fma_f32 v37, v36, v31, v45
    v_mov_b32_e64 v36, v38
    s_cmp_le_u32 s20, 2
    s_cbranch_scc1 L_Bh_w
    v_fma_f32 v48, v36, v30, v48
    v_fma_f32 v49, v37, v30, v49
    v_fma_f32 v38, -v37, v31, v48
    v_fma_f32 v37, v36, v31, v49
    v_mov_b32_e64 v36, v38
    s_cmp_le_u32 s20, 3
    s_cbranch_scc1 L_Bh_w
    v_fma_f32 v52, v36, v30, v52
    v_fma_f32 v53, v37, v30, v53
    v_fma_f32 v38, -v37, v31, v52
    v_fma_f32 v37, v36, v31, v53
    v_mov_b32_e64 v36, v38
    s_cmp_le_u32 s20, 4
    s_cbranch_scc1 L_Bh_w
    v_fma_f32 v56, v36, v30, v56
    v_fma_f32 v57, v37, v30, v57
    v_fma_f32 v38, -v37, v31, v56
    v_fma_f32 v37, v36, v31, v57
    v_mov_b32_e64 v36, v38
    s_cmp_le_u32 s20, 5
    s_cbranch_scc1 L_Bh_w
    v_fma_f32 v60, v36, v30, v60
    v_fma_f32 v61, v37, v30, v61
    v_fma_f32 v38, -v37, v31, v60
    v_fma_f32 v37, v36, v31, v61
    v_mov_b32_e64 v36, v38
    s_cmp_le_u32 s20, 6
    s_cbranch_scc1 L_Bh_w
    v_fma_f32 v64, v36, v30, v64
    v_fma_f32 v65, v37, v30, v65
    v_fma_f32 v38, -v37, v31, v64
    v_fma_f32 v37, v36, v31, v65
    v_mov_b32 v36, v38
L_Bh_w:
    s_mov_b64 exec, s[74:75]
    ds_write_b64 v3, v[36:37]
    s_mov_b64 exec, -1
    s_waitcnt lgkmcnt(0)
L_Bh_done:
    s_barrier
L_Bh_b3:
    s_barrier
L_B_phase2:
    v_and_b32 v1, 63, v0
    v_and_b32 v16, 15, v1
    v_lshrrev_b32 v17, 4, v1
    s_lshr_b32 s77, s3, 2
    s_lshr_b32 s21, s30, 2
    s_and_b32 s31, s29, 3
    s_lshl_b32 s31, s31, 2
    s_and_b32 s69, s30, 3
    s_add_u32 s20, s31, s69
    v_and_b32 v22, 7, v1
    v_xor_b32 v22, v22, v17
    v_lshrrev_b32 v23, 3, v1
    v_mul_u32_u24 v23, 1280, v23
    v_lshl_add_u32 v20, v22, 4, v23
    v_xor_b32_e64 v22, 4, v22
    v_lshl_add_u32 v21, v22, 4, v23
    s_lshr_b32 s26, s30, 2
    s_mul_i32 s26, s26, 102400
    s_mov_b32 s10, 819200
    s_cmp_lt_u32 s3, 6
    s_cbranch_scc0 L_B2_nopf
    s_and_b32 s31, s3, 1
    s_cmp_eq_u32 s31, 0
    s_cselect_b32 s8, s50, s52
    s_cselect_b32 s9, s51, s53
    s_mul_i32 s25, s31, 10240
    s_lshr_b32 s31, s3, 1
    s_mul_i32 s69, s31, 20480
    s_add_u32 s25, s25, s69
    s_lshl_b32 s31, s31, 7
    s_add_u32 s27, s26, s31
    s_add_u32 m0, s25, 102400
    s_add_u32 s23, s27, 640
    buffer_load_dwordx4 v20, s[8:11], s23 offen lds
    s_add_u32 m0, s25, 103424
    s_add_u32 s23, s27, 10880
    buffer_load_dwordx4 v21, s[8:11], s23 offen lds
    s_add_u32 m0, s25, 104448
    s_add_u32 s23, s27, 21120
    buffer_load_dwordx4 v20, s[8:11], s23 offen lds
    s_add_u32 m0, s25, 105472
    s_add_u32 s23, s27, 31360
    buffer_load_dwordx4 v21, s[8:11], s23 offen lds
    s_add_u32 m0, s25, 106496
    s_add_u32 s23, s27, 41600
    buffer_load_dwordx4 v20, s[8:11], s23 offen lds
    s_add_u32 m0, s25, 107520
    s_add_u32 s23, s27, 51840
    buffer_load_dwordx4 v21, s[8:11], s23 offen lds
    s_add_u32 m0, s25, 108544
    s_add_u32 s23, s27, 62080
    buffer_load_dwordx4 v20, s[8:11], s23 offen lds
    s_add_u32 m0, s25, 109568
    s_add_u32 s23, s27, 72320
    buffer_load_dwordx4 v21, s[8:11], s23 offen lds
    s_add_u32 m0, s25, 110592
    s_add_u32 s23, s27, 82560
    buffer_load_dwordx4 v20, s[8:11], s23 offen lds
    s_add_u32 m0, s25, 111616
    s_add_u32 s23, s27, 92800
    buffer_load_dwordx4 v21, s[8:11], s23 offen lds
L_B2_nopf:
    s_mov_b32 s28, s26
    s_mov_b32 s4, s40
    s_mov_b32 s5, s41
    s_lshl_b32 s31, s20, 3
    s_lshl_b32 s69, s67, 1
    s_add_u32 s31, s31, s69
    s_mul_i32 s31, s31, 40960
    s_mul_i32 s69, s77, 20480
    s_add_u32 s31, s31, s69
    s_add_u32 s42, s31, 4194304
    s_add_u32 s43, s42, 4096
    s_add_u32 s44, s42, 8192
    s_add_u32 s45, s42, 12288
    s_add_u32 s46, s42, 16384
    v_lshlrev_b32_e64 v5, 4, v1
    v_add_u32 v6, 40960, v5
    v_lshrrev_b32 v4, 1, v16
    v_xor_b32 v4, v4, v17
    v_lshlrev_b32_e64 v3, 7, v16
    s_mul_i32 s31, s77, 10240
    v_add_u32_e64 v3, s31, v3
    v_lshl_add_u32 v8, v4, 4, v3
    v_xor_b32_e64 v4, 4, v4
    v_lshl_add_u32 v9, v4, 4, v3
    ds_read_b128 v[128:131], v8 offset:0
    ds_read_b128 v[132:135], v8 offset:2048
    ds_read_b128 v[136:139], v8 offset:4096
    ds_read_b128 v[140:143], v8 offset:6144
    ds_read_b128 v[144:147], v8 offset:8192
    ds_read_b128 v[148:151], v9 offset:0
    ds_read_b128 v[152:155], v9 offset:2048
    ds_read_b128 v[156:159], v9 offset:4096
    ds_read_b128 v[160:163], v9 offset:6144
    ds_read_b128 v[164:167], v9 offset:8192
    ds_read_b128 v[168:171], v8 offset:20480
    ds_read_b128 v[172:175], v8 offset:22528
    ds_read_b128 v[176:179], v8 offset:24576
    ds_read_b128 v[180:183], v8 offset:26624
    ds_read_b128 v[184:187], v8 offset:28672
    ds_read_b128 v[188:191], v9 offset:20480
    ds_read_b128 v[192:195], v9 offset:22528
    ds_read_b128 v[196:199], v9 offset:24576
    ds_read_b128 v[200:203], v9 offset:26624
    ds_read_b128 v[204:207], v9 offset:28672
    s_lshr_b32 s31, s3, 1
    s_and_b32 s31, s31, 1
    s_cmp_eq_u32 s31, 0
    s_cselect_b32 s8, s50, s52
    s_cselect_b32 s9, s51, s53
    s_mul_i32 s25, s31, 10240
    s_mul_i32 s69, s77, 20480
    s_add_u32 s25, s25, s69
    s_and_b32 s31, s3, 1
    s_mul_i32 s69, s31, 5120
    s_add_u32 s25, s25, s69
    s_mul_i32 s69, s31, 51200
    s_add_u32 s28, s28, s69
    s_lshl_b32 s69, s77, 7
    s_add_u32 s28, s28, s69
    v_xor_b32 v22, v20, v21
    s_cmp_eq_u32 s31, 1
    s_cselect_b64 vcc, -1, 0
    v_mov_b32 v23, 0
    v_cndmask_b32 v22, v23, v22, vcc
    v_xor_b32_e64 v20, v20, v22
    v_xor_b32 v21, v21, v22
    s_waitcnt lgkmcnt(0)
    s_barrier
    s_add_u32 m0, s25, 0
    s_add_u32 s23, s28, 1024
    buffer_load_dwordx4 v20, s[8:11], s23 offen lds
    s_add_u32 m0, s25, 1024
    s_add_u32 s23, s28, 11264
    buffer_load_dwordx4 v21, s[8:11], s23 offen lds
    s_add_u32 m0, s25, 2048
    s_add_u32 s23, s28, 21504
    buffer_load_dwordx4 v20, s[8:11], s23 offen lds
    s_add_u32 m0, s25, 3072
    s_add_u32 s23, s28, 31744
    buffer_load_dwordx4 v21, s[8:11], s23 offen lds
    s_add_u32 m0, s25, 4096
    s_add_u32 s23, s28, 41984
    buffer_load_dwordx4 v20, s[8:11], s23 offen lds
    s_mov_b32 s16, s58
    s_mov_b32 s17, s59
    s_mov_b32 s18, 10485760
    s_mov_b32 s69, 3277
    s_mul_i32 s31, s67, 21504
    s_mul_i32 s68, s77, 5376
    s_add_u32 s31, s31, s68
    s_add_u32 s31, s31, 40960
    v_add_u32 v2, 0, v1
    v_mul_u32_u24 v3, 3277, v2
    v_lshrrev_b32 v3, 16, v3
    v_mul_u32_u24 v4, 20, v3
    v_sub_u32_e64 v2, v2, v4
    v_mul_u32_u24 v4, 336, v3
    v_lshl_add_u32 v4, v2, 4, v4
    v_add_u32_e64 v208, s31, v4
    v_mul_u32_u24 v4, 5120, v3
    v_lshl_add_u32 v213, v2, 4, v4
    v_mul_u32_u24 v4, 1280, v3
    v_lshl_add_u32 v218, v2, 3, v4
    v_lshlrev_b32 v223, 3, v2
    v_add_u32 v2, 64, v1
    v_mul_u32_u24 v3, 3277, v2
    v_lshrrev_b32 v3, 16, v3
    v_mul_u32_u24 v4, 20, v3
    v_sub_u32_e64 v2, v2, v4
    v_mul_u32_u24 v4, 336, v3
    v_lshl_add_u32 v4, v2, 4, v4
    v_add_u32_e64 v209, s31, v4
    v_mul_u32_u24 v4, 5120, v3
    v_lshl_add_u32 v214, v2, 4, v4
    v_mul_u32_u24 v4, 1280, v3
    v_lshl_add_u32 v219, v2, 3, v4
    v_lshlrev_b32_e64 v224, 3, v2
    v_add_u32 v2, 128, v1
    v_mul_u32_u24 v3, 3277, v2
    v_lshrrev_b32 v3, 16, v3
    v_mul_u32_u24 v4, 20, v3
    v_sub_u32_e64 v2, v2, v4
    v_mul_u32_u24 v4, 336, v3
    v_lshl_add_u32 v4, v2, 4, v4
    v_add_u32_e64 v210, s31, v4
    v_mul_u32_u24 v4, 5120, v3
    v_lshl_add_u32 v215, v2, 4, v4
    v_mul_u32_u24 v4, 1280, v3
    v_lshl_add_u32 v220, v2, 3, v4
    v_lshlrev_b32_e64 v225, 3, v2
    v_add_u32 v2, 192, v1
    v_mul_u32_u24 v3, 3277, v2
    v_lshrrev_b32 v3, 16, v3
    v_mul_u32_u24 v4, 20, v3
    v_sub_u32_e64 v2, v2, v4
    v_mul_u32_u24 v4, 336, v3
    v_lshl_add_u32 v4, v2, 4, v4
    v_add_u32_e64 v211, s31, v4
    v_mul_u32_u24 v4, 5120, v3
    v_lshl_add_u32 v216, v2, 4, v4
    v_mul_u32_u24 v4, 1280, v3
    v_lshl_add_u32 v221, v2, 3, v4
    v_lshlrev_b32_e64 v226, 3, v2
    v_add_u32 v2, 256, v1
    v_mul_u32_u24 v3, 3277, v2
    v_lshrrev_b32 v3, 16, v3
    v_mul_u32_u24 v4, 20, v3
    v_sub_u32_e64 v2, v2, v4
    v_mul_u32_u24 v4, 336, v3
    v_lshl_add_u32 v4, v2, 4, v4
    v_add_u32_e64 v212, s31, v4
    v_mul_u32_u24 v4, 5120, v3
    v_lshl_add_u32 v217, v2, 4, v4
    v_mul_u32_u24 v4, 1280, v3
    v_lshl_add_u32 v222, v2, 3, v4
    v_lshlrev_b32_e64 v227, 3, v2
    s_mul_i32 s31, s67, 21504
    s_mul_i32 s68, s77, 10752
    s_add_u32 s31, s31, s68
    s_add_u32 s31, s31, 40960
    v_mul_u32_u24 v7, 336, v16
    v_lshl_add_u32 v7, v17, 4, v7
    v_add_u32 v7, s31, v7
    s_lshl_b32 s26, s20, 7
    s_lshl_b32 s31, s67, 5
    s_add_u32 s26, s26, s31
    s_lshl_b32 s31, s77, 4
    s_add_u32 s27, s26, s31
    s_mul_i32 s26, s27, 5120
    s_mul_i32 s31, s21, 320
    s_add_u32 s26, s26, s31
    s_add_u32 s26, s26, 2560
    s_mul_i32 s24, s27, 1280
    s_mul_i32 s69, s21, 160
    s_add_u32 s24, s24, s69
    s_add_u32 s56, s56, s69
    s_addc_u32 s57, s57, 0
    s_cmp_eq_u32 s3, 0
    s_cbranch_scc0 L_rdy1_ok
    s_lshl_b32 s31, s20, 8
    s_add_u32 s31, s31, 8192
    v_and_b32 v2, 31, v1
    v_lshlrev_b32 v2, 3, v2
    s_mov_b32 s79, 0
L_rdy1:
    buffer_load_dwordx2 v[248:249], v2, s[12:15], s31 offen sc1
    s_waitcnt vmcnt(0)
    v_cmp_ne_u64 vcc, s[72:73], v[248:249]
    s_cbranch_vccz L_rdy1_ok
    s_sleep 2
    s_add_u32 s79, s79, 1
    s_cmp_lt_u32 s79, 0x8000
    s_cbranch_scc1 L_rdy1
L_rdy1_ok:
    s_waitcnt vmcnt(0)
    s_cmp_eq_u32 s3, 5
    s_cbranch_scc0 L_eb_28
    v_readfirstlane_b32 s31, v105
    s_nop 3
    s_cmp_eq_u32 s31, 255
    s_cbranch_scc0 L_eb_28
    v_mov_b32 v250, s72
    v_mov_b32_e64 v251, s73
    v_mov_b32 v249, 0
    s_mov_b64 exec, 1
    global_store_dwordx2 v249, v[250:251], s[62:63] sc1
    s_mov_b64 exec, -1
    s_waitcnt vmcnt(0)
L_eb_28:
    s_barrier
    buffer_load_dwordx4 v[64:67], v5, s[12:15], s42 offen offset:0
    buffer_load_dwordx4 v[68:71], v6, s[12:15], s42 offen offset:0
    buffer_load_dwordx4 v[72:75], v5, s[12:15], s42 offen offset:1024
    buffer_load_dwordx4 v[76:79], v6, s[12:15], s42 offen offset:1024
    buffer_load_dwordx4 v[80:83], v5, s[12:15], s42 offen offset:2048
    buffer_load_dwordx4 v[84:87], v6, s[12:15], s42 offen offset:2048
    buffer_load_dwordx4 v[88:91], v5, s[12:15], s42 offen offset:3072
    buffer_load_dwordx4 v[92:95], v6, s[12:15], s42 offen offset:3072
    buffer_load_dwordx4 v[96:99], v5, s[12:15], s43 offen offset:0
    buffer_load_dwordx4 v[100:103], v6, s[12:15], s43 offen offset:0
    buffer_load_dwordx4 v[104:107], v5, s[12:15], s43 offen offset:1024
    buffer_load_dwordx4 v[108:111], v6, s[12:15], s43 offen offset:1024
    s_waitcnt vmcnt(10)
    v_mfma_f32_16x16x32_bf16 v[24:27], v[128:131], v[64:67], 0
    v_mfma_f32_16x16x32_bf16 v[44:47], v[128:131], v[68:71], 0
    buffer_load_dwordx4 v[112:115], v5, s[12:15], s43 offen offset:2048
    v_mfma_f32_16x16x32_bf16 v[28:31], v[132:135], v[64:67], 0
    v_mfma_f32_16x16x32_bf16 v[48:51], v[132:135], v[68:71], 0
    v_mfma_f32_16x16x32_bf16 v[32:35], v[136:139], v[64:67], 0
    v_mfma_f32_16x16x32_bf16 v[52:55], v[136:139], v[68:71], 0
    buffer_load_dwordx4 v[116:119], v6, s[12:15], s43 offen offset:2048
    v_mfma_f32_16x16x32_bf16 v[36:39], v[140:143], v[64:67], 0
    v_mfma_f32_16x16x32_bf16 v[56:59], v[140:143], v[68:71], 0
    v_mfma_f32_16x16x32_bf16 v[40:43], v[144:147], v[64:67], 0
    v_mfma_f32_16x16x32_bf16 v[60:63], v[144:147], v[68:71], 0
    s_waitcnt vmcnt(10)
    s_nop 0
    v_mfma_f32_16x16x32_bf16 v[24:27], v[148:151], v[72:75], v[24:27]
    v_mfma_f32_16x16x32_bf16 v[44:47], v[148:151], v[76:79], v[44:47]
    buffer_load_dwordx4 v[120:123], v5, s[12:15], s43 offen offset:3072
    v_mfma_f32_16x16x32_bf16 v[28:31], v[152:155], v[72:75], v[28:31]
    v_mfma_f32_16x16x32_bf16 v[48:51], v[152:155], v[76:79], v[48:51]
    v_mfma_f32_16x16x32_bf16 v[32:35], v[156:159], v[72:75], v[32:35]
    v_mfma_f32_16x16x32_bf16 v[52:55], v[156:159], v[76:79], v[52:55]
    buffer_load_dwordx4 v[124:127], v6, s[12:15], s43 offen offset:3072
    v_mfma_f32_16x16x32_bf16 v[36:39], v[160:163], v[72:75], v[36:39]
    v_mfma_f32_16x16x32_bf16 v[56:59], v[160:163], v[76:79], v[56:59]
    v_mfma_f32_16x16x32_bf16 v[40:43], v[164:167], v[72:75], v[40:43]
    v_mfma_f32_16x16x32_bf16 v[60:63], v[164:167], v[76:79], v[60:63]
    s_waitcnt vmcnt(10)
    s_nop 0
    v_mfma_f32_16x16x32_bf16 v[24:27], v[168:171], v[80:83], v[24:27]
    v_mfma_f32_16x16x32_bf16 v[44:47], v[168:171], v[84:87], v[44:47]
    buffer_load_dwordx4 v[64:67], v5, s[12:15], s44 offen offset:0
    v_mfma_f32_16x16x32_bf16 v[28:31], v[172:175], v[80:83], v[28:31]
    v_mfma_f32_16x16x32_bf16 v[48:51], v[172:175], v[84:87], v[48:51]
    v_mfma_f32_16x16x32_bf16 v[32:35], v[176:179], v[80:83], v[32:35]
    v_mfma_f32_16x16x32_bf16 v[52:55], v[176:179], v[84:87], v[52:55]
    buffer_load_dwordx4 v[68:71], v6, s[12:15], s44 offen offset:0
    v_mfma_f32_16x16x32_bf16 v[36:39], v[180:183], v[80:83], v[36:39]
    v_mfma_f32_16x16x32_bf16 v[56:59], v[180:183], v[84:87], v[56:59]
    v_mfma_f32_16x16x32_bf16 v[40:43], v[184:187], v[80:83], v[40:43]
    v_mfma_f32_16x16x32_bf16 v[60:63], v[184:187], v[84:87], v[60:63]
    s_waitcnt vmcnt(10)
    s_nop 0
    v_mfma_f32_16x16x32_bf16 v[24:27], v[188:191], v[88:91], v[24:27]
    ds_read_b128 v[128:131], v8 offset:40960
    v_mfma_f32_16x16x32_bf16 v[44:47], v[188:191], v[92:95], v[44:47]
    buffer_load_dwordx4 v[72:75], v5, s[12:15], s44 offen offset:1024
    v_mfma_f32_16x16x32_bf16 v[28:31], v[192:195], v[88:91], v[28:31]
    ds_read_b128 v[132:135], v8 offset:43008
    v_mfma_f32_16x16x32_bf16 v[48:51], v[192:195], v[92:95], v[48:51]
    v_mfma_f32_16x16x32_bf16 v[32:35], v[196:199], v[88:91], v[32:35]
    ds_read_b128 v[136:139], v8 offset:45056
    v_mfma_f32_16x16x32_bf16 v[52:55], v[196:199], v[92:95], v[52:55]
    buffer_load_dwordx4 v[76:79], v6, s[12:15], s44 offen offset:1024
    v_mfma_f32_16x16x32_bf16 v[36:39], v[200:203], v[88:91], v[36:39]
    ds_read_b128 v[140:143], v8 offset:47104
    v_mfma_f32_16x16x32_bf16 v[56:59], v[200:203], v[92:95], v[56:59]
    v_mfma_f32_16x16x32_bf16 v[40:43], v[204:207], v[88:91], v[40:43]
    ds_read_b128 v[144:147], v8 offset:49152
    v_mfma_f32_16x16x32_bf16 v[60:63], v[204:207], v[92:95], v[60:63]
    s_waitcnt vmcnt(10)
    s_waitcnt lgkmcnt(4)
    v_mfma_f32_16x16x32_bf16 v[24:27], v[128:131], v[96:99], v[24:27]
    ds_read_b128 v[148:151], v9 offset:40960
    v_mfma_f32_16x16x32_bf16 v[44:47], v[128:131], v[100:103], v[44:47]
    buffer_load_dwordx4 v[80:83], v5, s[12:15], s44 offen offset:2048
    s_waitcnt lgkmcnt(4)
    s_nop 0
    v_mfma_f32_16x16x32_bf16 v[28:31], v[132:135], v[96:99], v[28:31]
    ds_read_b128 v[152:155], v9 offset:43008
    v_mfma_f32_16x16x32_bf16 v[48:51], v[132:135], v[100:103], v[48:51]
    s_waitcnt lgkmcnt(4)
    s_nop 0
    v_mfma_f32_16x16x32_bf16 v[32:35], v[136:139], v[96:99], v[32:35]
    ds_read_b128 v[156:159], v9 offset:45056
    v_mfma_f32_16x16x32_bf16 v[52:55], v[136:139], v[100:103], v[52:55]
    buffer_load_dwordx4 v[84:87], v6, s[12:15], s44 offen offset:2048
    s_waitcnt lgkmcnt(4)
    s_nop 0
    v_mfma_f32_16x16x32_bf16 v[36:39], v[140:143], v[96:99], v[36:39]
    ds_read_b128 v[160:163], v9 offset:47104
    v_mfma_f32_16x16x32_bf16 v[56:59], v[140:143], v[100:103], v[56:59]
    s_waitcnt lgkmcnt(4)
    s_nop 0
    v_mfma_f32_16x16x32_bf16 v[40:43], v[144:147], v[96:99], v[40:43]
    ds_read_b128 v[164:167], v9 offset:49152
    v_mfma_f32_16x16x32_bf16 v[60:63], v[144:147], v[100:103], v[60:63]
    s_waitcnt vmcnt(10)
    s_nop 0
    v_add_u32 v8, 61440, v8
    v_add_u32 v9, 61440, v9
    s_waitcnt lgkmcnt(4)
    s_nop 0
    v_mfma_f32_16x16x32_bf16 v[24:27], v[148:151], v[104:107], v[24:27]
    ds_read_b128 v[128:131], v8 offset:0
    v_mfma_f32_16x16x32_bf16 v[44:47], v[148:151], v[108:111], v[44:47]
    buffer_load_dwordx4 v[88:91], v5, s[12:15], s44 offen offset:3072
    s_waitcnt lgkmcnt(4)
    s_nop 0
    v_mfma_f32_16x16x32_bf16 v[28:31], v[152:155], v[104:107], v[28:31]
    ds_read_b128 v[132:135], v8 offset:2048
    v_mfma_f32_16x16x32_bf16 v[48:51], v[152:155], v[108:111], v[48:51]
    s_waitcnt lgkmcnt(4)
    s_nop 0
    v_mfma_f32_16x16x32_bf16 v[32:35], v[156:159], v[104:107], v[32:35]
    ds_read_b128 v[136:139], v8 offset:4096
    v_mfma_f32_16x16x32_bf16 v[52:55], v[156:159], v[108:111], v[52:55]
    buffer_load_dwordx4 v[92:95], v6, s[12:15], s44 offen offset:3072
    s_waitcnt lgkmcnt(4)
    s_nop 0
    v_mfma_f32_16x16x32_bf16 v[36:39], v[160:163], v[104:107], v[36:39]
    ds_read_b128 v[140:143], v8 offset:6144
    v_mfma_f32_16x16x32_bf16 v[56:59], v[160:163], v[108:111], v[56:59]
    s_waitcnt lgkmcnt(4)
    s_nop 0
    v_mfma_f32_16x16x32_bf16 v[40:43], v[164:167], v[104:107], v[40:43]
    ds_read_b128 v[144:147], v8 offset:8192
    v_mfma_f32_16x16x32_bf16 v[60:63], v[164:167], v[108:111], v[60:63]
    buffer_load_dwordx2 v[228:229], v218, s[4:7], s24 offen
    buffer_load_dwordx2 v[230:231], v219, s[4:7], s24 offen
    buffer_load_dwordx2 v[232:233], v220, s[4:7], s24 offen
    buffer_load_dwordx2 v[234:235], v221, s[4:7], s24 offen
    buffer_load_dwordx2 v[236:237], v222, s[4:7], s24 offen
    global_load_dwordx2 v[238:239], v223, s[56:57]
    global_load_dwordx2 v[240:241], v224, s[56:57]
    global_load_dwordx2 v[242:243], v225, s[56:57]
    global_load_dwordx2 v[244:245], v226, s[56:57]
    global_load_dwordx2 v[246:247], v227, s[56:57]
    s_waitcnt vmcnt(20)
    s_waitcnt lgkmcnt(4)
    v_mfma_f32_16x16x32_bf16 v[24:27], v[128:131], v[112:115], v[24:27]
    ds_read_b128 v[148:151], v9 offset:0
    v_mfma_f32_16x16x32_bf16 v[44:47], v[128:131], v[116:119], v[44:47]
    buffer_load_dwordx4 v[96:99], v5, s[12:15], s45 offen offset:0
    s_waitcnt lgkmcnt(4)
    s_nop 0
    v_mfma_f32_16x16x32_bf16 v[28:31], v[132:135], v[112:115], v[28:31]
    ds_read_b128 v[152:155], v9 offset:2048
    v_mfma_f32_16x16x32_bf16 v[48:51], v[132:135], v[116:119], v[48:51]
    s_waitcnt lgkmcnt(4)
    s_nop 0
    v_mfma_f32_16x16x32_bf16 v[32:35], v[136:139], v[112:115], v[32:35]
    ds_read_b128 v[156:159], v9 offset:4096
    v_mfma_f32_16x16x32_bf16 v[52:55], v[136:139], v[116:119], v[52:55]
    buffer_load_dwordx4 v[100:103], v6, s[12:15], s45 offen offset:0
    s_waitcnt lgkmcnt(4)
    s_nop 0
    v_mfma_f32_16x16x32_bf16 v[36:39], v[140:143], v[112:115], v[36:39]
    ds_read_b128 v[160:163], v9 offset:6144
    v_mfma_f32_16x16x32_bf16 v[56:59], v[140:143], v[116:119], v[56:59]
    s_waitcnt lgkmcnt(4)
    s_nop 0
    v_mfma_f32_16x16x32_bf16 v[40:43], v[144:147], v[112:115], v[40:43]
    ds_read_b128 v[164:167], v9 offset:8192
    v_mfma_f32_16x16x32_bf16 v[60:63], v[144:147], v[116:119], v[60:63]
    s_waitcnt vmcnt(20)
    s_waitcnt lgkmcnt(4)
    v_mfma_f32_16x16x32_bf16 v[24:27], v[148:151], v[120:123], v[24:27]
    ds_read_b128 v[128:131], v8 offset:20480
    v_mfma_f32_16x16x32_bf16 v[44:47], v[148:151], v[124:127], v[44:47]
    buffer_load_dwordx4 v[104:107], v5, s[12:15], s45 offen offset:1024
    s_waitcnt lgkmcnt(4)
    s_nop 0
    v_mfma_f32_16x16x32_bf16 v[28:31], v[152:155], v[120:123], v[28:31]
    ds_read_b128 v[132:135], v8 offset:22528
    v_mfma_f32_16x16x32_bf16 v[48:51], v[152:155], v[124:127], v[48:51]
    s_waitcnt lgkmcnt(4)
    s_nop 0
    v_mfma_f32_16x16x32_bf16 v[32:35], v[156:159], v[120:123], v[32:35]
    ds_read_b128 v[136:139], v8 offset:24576
    v_mfma_f32_16x16x32_bf16 v[52:55], v[156:159], v[124:127], v[52:55]
    buffer_load_dwordx4 v[108:111], v6, s[12:15], s45 offen offset:1024
    s_waitcnt lgkmcnt(4)
    s_nop 0
    v_mfma_f32_16x16x32_bf16 v[36:39], v[160:163], v[120:123], v[36:39]
    ds_read_b128 v[140:143], v8 offset:26624
    v_mfma_f32_16x16x32_bf16 v[56:59], v[160:163], v[124:127], v[56:59]
    s_waitcnt lgkmcnt(4)
    s_nop 0
    v_mfma_f32_16x16x32_bf16 v[40:43], v[164:167], v[120:123], v[40:43]
    ds_read_b128 v[144:147], v8 offset:28672
    v_mfma_f32_16x16x32_bf16 v[60:63], v[164:167], v[124:127], v[60:63]
    s_waitcnt vmcnt(20)
    s_waitcnt lgkmcnt(4)
    v_mfma_f32_16x16x32_bf16 v[24:27], v[128:131], v[64:67], v[24:27]
    ds_read_b128 v[148:151], v9 offset:20480
    v_mfma_f32_16x16x32_bf16 v[44:47], v[128:131], v[68:71], v[44:47]
    buffer_load_dwordx4 v[112:115], v5, s[12:15], s45 offen offset:2048
    s_waitcnt lgkmcnt(4)
    s_nop 0
    v_mfma_f32_16x16x32_bf16 v[28:31], v[132:135], v[64:67], v[28:31]
    ds_read_b128 v[152:155], v9 offset:22528
    v_mfma_f32_16x16x32_bf16 v[48:51], v[132:135], v[68:71], v[48:51]
    s_waitcnt lgkmcnt(4)
    s_nop 0
    v_mfma_f32_16x16x32_bf16 v[32:35], v[136:139], v[64:67], v[32:35]
    ds_read_b128 v[156:159], v9 offset:24576
    v_mfma_f32_16x16x32_bf16 v[52:55], v[136:139], v[68:71], v[52:55]
    buffer_load_dwordx4 v[116:119], v6, s[12:15], s45 offen offset:2048
    s_waitcnt lgkmcnt(4)
    s_nop 0
    v_mfma_f32_16x16x32_bf16 v[36:39], v[140:143], v[64:67], v[36:39]
    ds_read_b128 v[160:163], v9 offset:26624
    v_mfma_f32_16x16x32_bf16 v[56:59], v[140:143], v[68:71], v[56:59]
    s_waitcnt lgkmcnt(4)
    s_nop 0
    v_mfma_f32_16x16x32_bf16 v[40:43], v[144:147], v[64:67], v[40:43]
    ds_read_b128 v[164:167], v9 offset:28672
    v_mfma_f32_16x16x32_bf16 v[60:63], v[144:147], v[68:71], v[60:63]
    s_waitcnt vmcnt(20)
    s_waitcnt lgkmcnt(4)
    v_mfma_f32_16x16x32_bf16 v[24:27], v[148:151], v[72:75], v[24:27]
    ds_read_b128 v[128:131], v8 offset:40960
    v_mfma_f32_16x16x32_bf16 v[44:47], v[148:151], v[76:79], v[44:47]
    buffer_load_dwordx4 v[120:123], v5, s[12:15], s45 offen offset:3072
    s_waitcnt lgkmcnt(4)
    s_nop 0
    v_mfma_f32_16x16x32_bf16 v[28:31], v[152:155], v[72:75], v[28:31]
    ds_read_b128 v[132:135], v8 offset:43008
    v_mfma_f32_16x16x32_bf16 v[48:51], v[152:155], v[76:79], v[48:51]
    s_waitcnt lgkmcnt(4)
    s_nop 0
    v_mfma_f32_16x16x32_bf16 v[32:35], v[156:159], v[72:75], v[32:35]
    ds_read_b128 v[136:139], v8 offset:45056
    v_mfma_f32_16x16x32_bf16 v[52:55], v[156:159], v[76:79], v[52:55]
    buffer_load_dwordx4 v[124:127], v6, s[12:15], s45 offen offset:3072
    s_waitcnt lgkmcnt(4)
    s_nop 0
    v_mfma_f32_16x16x32_bf16 v[36:39], v[160:163], v[72:75], v[36:39]
    ds_read_b128 v[140:143], v8 offset:47104
    v_mfma_f32_16x16x32_bf16 v[56:59], v[160:163], v[76:79], v[56:59]
    s_waitcnt lgkmcnt(4)
    s_nop 0
    v_mfma_f32_16x16x32_bf16 v[40:43], v[164:167], v[72:75], v[40:43]
    ds_read_b128 v[144:147], v8 offset:49152
    v_mfma_f32_16x16x32_bf16 v[60:63], v[164:167], v[76:79], v[60:63]
    s_waitcnt vmcnt(20)
    s_waitcnt lgkmcnt(4)
    v_mfma_f32_16x16x32_bf16 v[24:27], v[128:131], v[80:83], v[24:27]
    ds_read_b128 v[148:151], v9 offset:40960
    v_mfma_f32_16x16x32_bf16 v[44:47], v[128:131], v[84:87], v[44:47]
    buffer_load_dwordx4 v[64:67], v5, s[12:15], s46 offen offset:0
    s_waitcnt lgkmcnt(4)
    s_nop 0
    v_mfma_f32_16x16x32_bf16 v[28:31], v[132:135], v[80:83], v[28:31]
    ds_read_b128 v[152:155], v9 offset:43008
    v_mfma_f32_16x16x32_bf16 v[48:51], v[132:135], v[84:87], v[48:51]
    s_waitcnt lgkmcnt(4)
    s_nop 0
    v_mfma_f32_16x16x32_bf16 v[32:35], v[136:139], v[80:83], v[32:35]
    ds_read_b128 v[156:159], v9 offset:45056
    v_mfma_f32_16x16x32_bf16 v[52:55], v[136:139], v[84:87], v[52:55]
    buffer_load_dwordx4 v[68:71], v6, s[12:15], s46 offen offset:0
    s_waitcnt lgkmcnt(4)
    s_nop 0
    v_mfma_f32_16x16x32_bf16 v[36:39], v[140:143], v[80:83], v[36:39]
    ds_read_b128 v[160:163], v9 offset:47104
    v_mfma_f32_16x16x32_bf16 v[56:59], v[140:143], v[84:87], v[56:59]
    s_waitcnt lgkmcnt(4)
    s_nop 0
    v_mfma_f32_16x16x32_bf16 v[40:43], v[144:147], v[80:83], v[40:43]
    ds_read_b128 v[164:167], v9 offset:49152
    v_mfma_f32_16x16x32_bf16 v[60:63], v[144:147], v[84:87], v[60:63]
    s_waitcnt vmcnt(20)
    s_nop 0
    v_add_u32 v8, 61440, v8
    v_add_u32 v9, 61440, v9
    s_waitcnt lgkmcnt(4)
    s_nop 0
    v_mfma_f32_16x16x32_bf16 v[24:27], v[148:151], v[88:91], v[24:27]
    ds_read_b128 v[128:131], v8 offset:0
    v_mfma_f32_16x16x32_bf16 v[44:47], v[148:151], v[92:95], v[44:47]
    buffer_load_dwordx4 v[72:75], v5, s[12:15], s46 offen offset:1024
    s_waitcnt lgkmcnt(4)
    s_nop 0
    v_mfma_f32_16x16x32_bf16 v[28:31], v[152:155], v[88:91], v[28:31]
    ds_read_b128 v[132:135], v8 offset:2048
    v_mfma_f32_16x16x32_bf16 v[48:51], v[152:155], v[92:95], v[48:51]
    s_waitcnt lgkmcnt(4)
    s_nop 0
    v_mfma_f32_16x16x32_bf16 v[32:35], v[156:159], v[88:91], v[32:35]
    ds_read_b128 v[136:139], v8 offset:4096
    v_mfma_f32_16x16x32_bf16 v[52:55], v[156:159], v[92:95], v[52:55]
    buffer_load_dwordx4 v[76:79], v6, s[12:15], s46 offen offset:1024
    s_waitcnt lgkmcnt(4)
    s_nop 0
    v_mfma_f32_16x16x32_bf16 v[36:39], v[160:163], v[88:91], v[36:39]
    ds_read_b128 v[140:143], v8 offset:6144
    v_mfma_f32_16x16x32_bf16 v[56:59], v[160:163], v[92:95], v[56:59]
    s_waitcnt lgkmcnt(4)
    s_nop 0
    v_mfma_f32_16x16x32_bf16 v[40:43], v[164:167], v[88:91], v[40:43]
    ds_read_b128 v[144:147], v8 offset:8192
    v_mfma_f32_16x16x32_bf16 v[60:63], v[164:167], v[92:95], v[60:63]
    s_waitcnt vmcnt(12)
    s_waitcnt vmcnt(10)
    s_waitcnt lgkmcnt(4)
    s_nop 0
    v_mfma_f32_16x16x32_bf16 v[24:27], v[128:131], v[96:99], v[24:27]
    ds_read_b128 v[148:151], v9 offset:0
    v_mfma_f32_16x16x32_bf16 v[44:47], v[128:131], v[100:103], v[44:47]
    v_lshlrev_b32_e64 v10, 16, v228
    v_and_b32 v11, 0xffff0000, v228
    buffer_load_dwordx4 v[80:83], v5, s[12:15], s46 offen offset:2048
    s_waitcnt lgkmcnt(4)
    s_nop 0
    v_mfma_f32_16x16x32_bf16 v[28:31], v[132:135], v[96:99], v[28:31]
    ds_read_b128 v[152:155], v9 offset:2048
    v_mfma_f32_16x16x32_bf16 v[48:51], v[132:135], v[100:103], v[48:51]
    v_lshlrev_b32_e64 v12, 16, v238
    v_and_b32 v13, 0xffff0000, v238
    s_waitcnt lgkmcnt(4)
    s_nop 0
    v_mfma_f32_16x16x32_bf16 v[32:35], v[136:139], v[96:99], v[32:35]
    ds_read_b128 v[156:159], v9 offset:4096
    v_mfma_f32_16x16x32_bf16 v[52:55], v[136:139], v[100:103], v[52:55]
    v_mul_f32 v10, v10, v12
    v_mul_f32 v11, v11, v13
    buffer_load_dwordx4 v[84:87], v6, s[12:15], s46 offen offset:2048
    s_waitcnt lgkmcnt(4)
    s_nop 0
    v_mfma_f32_16x16x32_bf16 v[36:39], v[140:143], v[96:99], v[36:39]
    ds_read_b128 v[160:163], v9 offset:6144
    v_mfma_f32_16x16x32_bf16 v[56:59], v[140:143], v[100:103], v[56:59]
    v_cvt_pk_bf16_f32 v228, v10, v11
    v_lshlrev_b32 v10, 16, v229
    s_waitcnt lgkmcnt(4)
    v_mfma_f32_16x16x32_bf16 v[40:43], v[144:147], v[96:99], v[40:43]
    ds_read_b128 v[164:167], v9 offset:8192
    v_mfma_f32_16x16x32_bf16 v[60:63], v[144:147], v[100:103], v[60:63]
    v_and_b32 v11, 0xffff0000, v229
    v_lshlrev_b32_e64 v12, 16, v239
    s_waitcnt vmcnt(10)
    s_waitcnt lgkmcnt(4)
    v_mfma_f32_16x16x32_bf16 v[24:27], v[148:151], v[104:107], v[24:27]
    ds_read_b128 v[128:131], v8 offset:20480
    v_mfma_f32_16x16x32_bf16 v[44:47], v[148:151], v[108:111], v[44:47]
    v_and_b32 v13, 0xffff0000, v239
    v_mul_f32_e64 v10, v10, v12
    buffer_load_dwordx4 v[88:91], v5, s[12:15], s46 offen offset:3072
    s_waitcnt lgkmcnt(4)
    s_nop 0
    v_mfma_f32_16x16x32_bf16 v[28:31], v[152:155], v[104:107], v[28:31]
    ds_read_b128 v[132:135], v8 offset:22528
    v_mfma_f32_16x16x32_bf16 v[48:51], v[152:155], v[108:111], v[48:51]
    v_mul_f32_e64 v11, v11, v13
    v_cvt_pk_bf16_f32 v229, v10, v11
    s_waitcnt lgkmcnt(4)
    s_nop 0
    v_mfma_f32_16x16x32_bf16 v[32:35], v[156:159], v[104:107], v[32:35]
    ds_read_b128 v[136:139], v8 offset:24576
    v_mfma_f32_16x16x32_bf16 v[52:55], v[156:159], v[108:111], v[52:55]
    v_lshlrev_b32_e64 v10, 16, v230
    v_and_b32 v11, 0xffff0000, v230
    buffer_load_dwordx4 v[92:95], v6, s[12:15], s46 offen offset:3072
    s_waitcnt lgkmcnt(4)
    s_nop 0
    v_mfma_f32_16x16x32_bf16 v[36:39], v[160:163], v[104:107], v[36:39]
    ds_read_b128 v[140:143], v8 offset:26624
    v_mfma_f32_16x16x32_bf16 v[56:59], v[160:163], v[108:111], v[56:59]
    v_lshlrev_b32_e64 v12, 16, v240
    v_and_b32 v13, 0xffff0000, v240
    s_waitcnt lgkmcnt(4)
    s_nop 0
    v_mfma_f32_16x16x32_bf16 v[40:43], v[164:167], v[104:107], v[40:43]
    ds_read_b128 v[144:147], v8 offset:28672
    v_mfma_f32_16x16x32_bf16 v[60:63], v[164:167], v[108:111], v[60:63]
    v_mul_f32 v10, v10, v12
    v_mul_f32 v11, v11, v13
    s_waitcnt vmcnt(10)
    s_waitcnt lgkmcnt(4)
    v_mfma_f32_16x16x32_bf16 v[24:27], v[128:131], v[112:115], v[24:27]
    ds_read_b128 v[148:151], v9 offset:20480
    v_mfma_f32_16x16x32_bf16 v[44:47], v[128:131], v[116:119], v[44:47]
    v_cvt_pk_bf16_f32 v230, v10, v11
    v_lshlrev_b32 v10, 16, v231
    s_waitcnt lgkmcnt(4)
    v_mfma_f32_16x16x32_bf16 v[28:31], v[132:135], v[112:115], v[28:31]
    ds_read_b128 v[152:155], v9 offset:22528
    v_mfma_f32_16x16x32_bf16 v[48:51], v[132:135], v[116:119], v[48:51]
    v_and_b32 v11, 0xffff0000, v231
    v_lshlrev_b32 v12, 16, v241
    s_waitcnt lgkmcnt(4)
    v_mfma_f32_16x16x32_bf16 v[32:35], v[136:139], v[112:115], v[32:35]
    ds_read_b128 v[156:159], v9 offset:24576
    v_mfma_f32_16x16x32_bf16 v[52:55], v[136:139], v[116:119], v[52:55]
    v_and_b32 v13, 0xffff0000, v241
    v_mul_f32 v10, v10, v12
    s_waitcnt lgkmcnt(4)
    v_mfma_f32_16x16x32_bf16 v[36:39], v[140:143], v[112:115], v[36:39]
    ds_read_b128 v[160:163], v9 offset:26624
    v_mfma_f32_16x16x32_bf16 v[56:59], v[140:143], v[116:119], v[56:59]
    v_mul_f32_e64 v11, v11, v13
    v_cvt_pk_bf16_f32 v231, v10, v11
    s_waitcnt lgkmcnt(4)
    s_nop 0
    v_mfma_f32_16x16x32_bf16 v[40:43], v[144:147], v[112:115], v[40:43]
    ds_read_b128 v[164:167], v9 offset:28672
    v_mfma_f32_16x16x32_bf16 v[60:63], v[144:147], v[116:119], v[60:63]
    v_lshlrev_b32_e64 v10, 16, v232
    v_and_b32 v11, 0xffff0000, v232
    s_waitcnt vmcnt(8)
    s_nop 0
    v_add_u32 v8, 4294844416, v8
    v_add_u32 v9, 4294844416, v9
    s_waitcnt lgkmcnt(4)
    s_nop 0
    v_mfma_f32_16x16x32_bf16 v[24:27], v[148:151], v[120:123], v[24:27]
    ds_read_b128 v[128:131], v8 offset:0
    v_mfma_f32_16x16x32_bf16 v[44:47], v[148:151], v[124:127], v[44:47]
    v_lshlrev_b32_e64 v12, 16, v242
    v_and_b32 v13, 0xffff0000, v242
    s_waitcnt lgkmcnt(4)
    s_nop 0
    v_mfma_f32_16x16x32_bf16 v[28:31], v[152:155], v[120:123], v[28:31]
    ds_read_b128 v[132:135], v8 offset:2048
    v_mfma_f32_16x16x32_bf16 v[48:51], v[152:155], v[124:127], v[48:51]
    v_mul_f32_e64 v10, v10, v12
    v_mul_f32 v11, v11, v13
    s_waitcnt lgkmcnt(4)
    v_mfma_f32_16x16x32_bf16 v[32:35], v[156:159], v[120:123], v[32:35]
    ds_read_b128 v[136:139], v8 offset:4096
    v_mfma_f32_16x16x32_bf16 v[52:55], v[156:159], v[124:127], v[52:55]
    v_cvt_pk_bf16_f32 v232, v10, v11
    v_lshlrev_b32 v10, 16, v233
    s_waitcnt lgkmcnt(4)
    v_mfma_f32_16x16x32_bf16 v[36:39], v[160:163], v[120:123], v[36:39]
    ds_read_b128 v[140:143], v8 offset:6144
    v_mfma_f32_16x16x32_bf16 v[56:59], v[160:163], v[124:127], v[56:59]
    v_and_b32 v11, 0xffff0000, v233
    v_lshlrev_b32 v12, 16, v243
    s_waitcnt lgkmcnt(4)
    v_mfma_f32_16x16x32_bf16 v[40:43], v[164:167], v[120:123], v[40:43]
    ds_read_b128 v[144:147], v8 offset:8192
    v_mfma_f32_16x16x32_bf16 v[60:63], v[164:167], v[124:127], v[60:63]
    v_and_b32 v13, 0xffff0000, v243
    v_mul_f32_e64 v10, v10, v12
    s_waitcnt vmcnt(6)
    s_waitcnt lgkmcnt(4)
    v_mfma_f32_16x16x32_bf16 v[24:27], v[128:131], v[64:67], v[24:27]
    ds_read_b128 v[148:151], v9 offset:0
    v_mfma_f32_16x16x32_bf16 v[44:47], v[128:131], v[68:71], v[44:47]
    v_mul_f32_e64 v11, v11, v13
    v_cvt_pk_bf16_f32 v233, v10, v11
    s_waitcnt lgkmcnt(4)
    s_nop 0
    v_mfma_f32_16x16x32_bf16 v[28:31], v[132:135], v[64:67], v[28:31]
    ds_read_b128 v[152:155], v9 offset:2048
    v_mfma_f32_16x16x32_bf16 v[48:51], v[132:135], v[68:71], v[48:51]
    v_lshlrev_b32_e64 v10, 16, v234
    v_and_b32 v11, 0xffff0000, v234
    s_waitcnt lgkmcnt(4)
    s_nop 0
    v_mfma_f32_16x16x32_bf16 v[32:35], v[136:139], v[64:67], v[32:35]
    ds_read_b128 v[156:159], v9 offset:4096
    v_mfma_f32_16x16x32_bf16 v[52:55], v[136:139], v[68:71], v[52:55]
    v_lshlrev_b32_e64 v12, 16, v244
    v_and_b32 v13, 0xffff0000, v244
    s_waitcnt lgkmcnt(4)
    s_nop 0
    v_mfma_f32_16x16x32_bf16 v[36:39], v[140:143], v[64:67], v[36:39]
    ds_read_b128 v[160:163], v9 offset:6144
    v_mfma_f32_16x16x32_bf16 v[56:59], v[140:143], v[68:71], v[56:59]
    v_mul_f32_e64 v10, v10, v12
    v_mul_f32 v11, v11, v13
    s_waitcnt lgkmcnt(4)
    v_mfma_f32_16x16x32_bf16 v[40:43], v[144:147], v[64:67], v[40:43]
    ds_read_b128 v[164:167], v9 offset:8192
    v_mfma_f32_16x16x32_bf16 v[60:63], v[144:147], v[68:71], v[60:63]
    v_cvt_pk_bf16_f32 v234, v10, v11
    v_lshlrev_b32_e64 v10, 16, v235
    s_waitcnt vmcnt(4)
    s_waitcnt lgkmcnt(4)
    v_mfma_f32_16x16x32_bf16 v[24:27], v[148:151], v[72:75], v[24:27]
    ds_read_b128 v[128:131], v8 offset:20480
    v_mfma_f32_16x16x32_bf16 v[44:47], v[148:151], v[76:79], v[44:47]
    v_and_b32 v11, 0xffff0000, v235
    v_lshlrev_b32 v12, 16, v245
    s_waitcnt lgkmcnt(4)
    v_mfma_f32_16x16x32_bf16 v[28:31], v[152:155], v[72:75], v[28:31]
    ds_read_b128 v[132:135], v8 offset:22528
    v_mfma_f32_16x16x32_bf16 v[48:51], v[152:155], v[76:79], v[48:51]
    v_and_b32 v13, 0xffff0000, v245
    v_mul_f32 v10, v10, v12
    s_waitcnt lgkmcnt(4)
    v_mfma_f32_16x16x32_bf16 v[32:35], v[156:159], v[72:75], v[32:35]
    ds_read_b128 v[136:139], v8 offset:24576
    v_mfma_f32_16x16x32_bf16 v[52:55], v[156:159], v[76:79], v[52:55]
    v_mul_f32_e64 v11, v11, v13
    v_cvt_pk_bf16_f32 v235, v10, v11
    s_waitcnt lgkmcnt(4)
    s_nop 0
    v_mfma_f32_16x16x32_bf16 v[36:39], v[160:163], v[72:75], v[36:39]
    ds_read_b128 v[140:143], v8 offset:26624
    v_mfma_f32_16x16x32_bf16 v[56:59], v[160:163], v[76:79], v[56:59]
    v_lshlrev_b32_e64 v10, 16, v236
    v_and_b32 v11, 0xffff0000, v236
    s_waitcnt lgkmcnt(4)
    s_nop 0
    v_mfma_f32_16x16x32_bf16 v[40:43], v[164:167], v[72:75], v[40:43]
    ds_read_b128 v[144:147], v8 offset:28672
    v_mfma_f32_16x16x32_bf16 v[60:63], v[164:167], v[76:79], v[60:63]
    v_lshlrev_b32_e64 v12, 16, v246
    v_and_b32 v13, 0xffff0000, v246
    s_waitcnt vmcnt(2)
    s_waitcnt lgkmcnt(4)
    v_mfma_f32_16x16x32_bf16 v[24:27], v[128:131], v[80:83], v[24:27]
    ds_read_b128 v[148:151], v9 offset:20480
    v_mfma_f32_16x16x32_bf16 v[44:47], v[128:131], v[84:87], v[44:47]
    v_mul_f32_e64 v10, v10, v12
    v_mul_f32 v11, v11, v13
    s_waitcnt lgkmcnt(4)
    v_mfma_f32_16x16x32_bf16 v[28:31], v[132:135], v[80:83], v[28:31]
    ds_read_b128 v[152:155], v9 offset:22528
    v_mfma_f32_16x16x32_bf16 v[48:51], v[132:135], v[84:87], v[48:51]
    v_cvt_pk_bf16_f32 v236, v10, v11
    v_lshlrev_b32 v10, 16, v237
    s_waitcnt lgkmcnt(4)
    v_mfma_f32_16x16x32_bf16 v[32:35], v[136:139], v[80:83], v[32:35]
    ds_read_b128 v[156:159], v9 offset:24576
    v_mfma_f32_16x16x32_bf16 v[52:55], v[136:139], v[84:87], v[52:55]
    v_and_b32 v11, 0xffff0000, v237
    v_lshlrev_b32 v12, 16, v247
    s_waitcnt lgkmcnt(4)
    v_mfma_f32_16x16x32_bf16 v[36:39], v[140:143], v[80:83], v[36:39]
    ds_read_b128 v[160:163], v9 offset:26624
    v_mfma_f32_16x16x32_bf16 v[56:59], v[140:143], v[84:87], v[56:59]
    v_and_b32 v13, 0xffff0000, v247
    v_mul_f32 v10, v10, v12
    s_waitcnt lgkmcnt(4)
    v_mfma_f32_16x16x32_bf16 v[40:43], v[144:147], v[80:83], v[40:43]
    ds_read_b128 v[164:167], v9 offset:28672
    v_mfma_f32_16x16x32_bf16 v[60:63], v[144:147], v[84:87], v[60:63]
    v_mul_f32_e64 v11, v11, v13
    v_cvt_pk_bf16_f32 v237, v10, v11
    s_waitcnt vmcnt(0)
    s_waitcnt lgkmcnt(4)
    v_mfma_f32_16x16x32_bf16 v[24:27], v[148:151], v[88:91], v[24:27]
    v_mfma_f32_16x16x32_bf16 v[44:47], v[148:151], v[92:95], v[44:47]
    s_waitcnt lgkmcnt(3)
    s_nop 0
    v_mfma_f32_16x16x32_bf16 v[28:31], v[152:155], v[88:91], v[28:31]
    v_mfma_f32_16x16x32_bf16 v[48:51], v[152:155], v[92:95], v[48:51]
    s_waitcnt lgkmcnt(2)
    s_nop 0
    v_mfma_f32_16x16x32_bf16 v[32:35], v[156:159], v[88:91], v[32:35]
    v_mfma_f32_16x16x32_bf16 v[52:55], v[156:159], v[92:95], v[52:55]
    s_waitcnt lgkmcnt(1)
    s_nop 0
    v_mfma_f32_16x16x32_bf16 v[36:39], v[160:163], v[88:91], v[36:39]
    v_mfma_f32_16x16x32_bf16 v[56:59], v[160:163], v[92:95], v[56:59]
    s_waitcnt lgkmcnt(0)
    s_nop 0
    v_mfma_f32_16x16x32_bf16 v[40:43], v[164:167], v[88:91], v[40:43]
    v_mfma_f32_16x16x32_bf16 v[60:63], v[164:167], v[92:95], v[60:63]
    v_lshlrev_b32_e64 v168, 16, v228
    v_and_b32 v169, 0xffff0000, v228
    v_lshlrev_b32_e64 v170, 16, v229
    v_and_b32 v171, 0xffff0000, v229
    v_lshlrev_b32_e64 v172, 16, v230
    v_and_b32 v173, 0xffff0000, v230
    v_lshlrev_b32_e64 v174, 16, v231
    v_and_b32 v175, 0xffff0000, v231
    v_lshlrev_b32_e64 v176, 16, v232
    v_and_b32 v177, 0xffff0000, v232
    v_lshlrev_b32_e64 v178, 16, v233
    v_and_b32 v179, 0xffff0000, v233
    v_lshlrev_b32_e64 v180, 16, v234
    v_and_b32 v181, 0xffff0000, v234
    v_lshlrev_b32_e64 v182, 16, v235
    v_and_b32 v183, 0xffff0000, v235
    v_lshlrev_b32_e64 v184, 16, v236
    v_and_b32 v185, 0xffff0000, v236
    v_lshlrev_b32_e64 v186, 16, v237
    v_and_b32 v187, 0xffff0000, v237
    s_nop 4
    s_barrier
    ds_write_b128 v7, v[24:27] offset:0
    ds_write_b128 v7, v[28:31] offset:64
    ds_write_b128 v7, v[32:35] offset:128
    ds_write_b128 v7, v[36:39] offset:192
    ds_write_b128 v7, v[40:43] offset:256
    ds_write_b128 v7, v[44:47] offset:5376
    ds_write_b128 v7, v[48:51] offset:5440
    ds_write_b128 v7, v[52:55] offset:5504
    ds_write_b128 v7, v[56:59] offset:5568
    ds_write_b128 v7, v[60:63] offset:5632
    s_waitcnt lgkmcnt(0)
    s_barrier
    ds_read_b128 v[64:67], v208
    ds_read_b128 v[68:71], v208 offset:10752
    ds_read_b128 v[72:75], v209
    ds_read_b128 v[76:79], v209 offset:10752
    ds_read_b128 v[80:83], v210
    ds_read_b128 v[84:87], v210 offset:10752
    ds_read_b128 v[88:91], v211
    ds_read_b128 v[92:95], v211 offset:10752
    ds_read_b128 v[96:99], v212
    ds_read_b128 v[100:103], v212 offset:10752
    s_waitcnt lgkmcnt(8)
    v_add_f32 v64, v64, v68
    v_add_f32 v65, v65, v69
    v_add_f32 v66, v66, v70
    v_add_f32 v67, v67, v71
    v_add_f32 v64, v64, v168
    v_add_f32 v65, v65, v169
    v_add_f32 v66, v66, v170
    v_add_f32_e64 v67, v67, v171
    buffer_store_dwordx4 v[64:67], v213, s[16:19], s26 offen sc1
    s_waitcnt lgkmcnt(6)
    v_add_f32 v72, v72, v76
    v_add_f32 v73, v73, v77
    v_add_f32 v74, v74, v78
    v_add_f32 v75, v75, v79
    v_add_f32 v72, v72, v172
    v_add_f32 v73, v73, v173
    v_add_f32 v74, v74, v174
    v_add_f32_e64 v75, v75, v175
    buffer_store_dwordx4 v[72:75], v214, s[16:19], s26 offen sc1
    s_waitcnt lgkmcnt(4)
    v_add_f32 v80, v80, v84
    v_add_f32 v81, v81, v85
    v_add_f32 v82, v82, v86
    v_add_f32 v83, v83, v87
    v_add_f32 v80, v80, v176
    v_add_f32 v81, v81, v177
    v_add_f32 v82, v82, v178
    v_add_f32_e64 v83, v83, v179
    buffer_store_dwordx4 v[80:83], v215, s[16:19], s26 offen sc1
    s_waitcnt lgkmcnt(2)
    v_add_f32 v88, v88, v92
    v_add_f32 v89, v89, v93
    v_add_f32 v90, v90, v94
    v_add_f32 v91, v91, v95
    v_add_f32 v88, v88, v180
    v_add_f32 v89, v89, v181
    v_add_f32 v90, v90, v182
    v_add_f32_e64 v91, v91, v183
    buffer_store_dwordx4 v[88:91], v216, s[16:19], s26 offen sc1
    s_waitcnt lgkmcnt(0)
    v_add_f32 v96, v96, v100
    v_add_f32 v97, v97, v101
    v_add_f32 v98, v98, v102
    v_add_f32 v99, v99, v103
    v_add_f32 v96, v96, v184
    v_add_f32 v97, v97, v185
    v_add_f32 v98, v98, v186
    v_add_f32_e64 v99, v99, v187
    buffer_store_dwordx4 v[96:99], v217, s[16:19], s26 offen sc1
L_fin:
L_end:
    s_endpgm
    .fill 10500, 4, 0xBF800000
.section .rodata,"a"
.p2align 6
.amdhsa_kernel concat_heads__linear_kernel_hedgehog__ssm_conv_s5__prompt_kernel
  .amdhsa_next_free_vgpr 256
  .amdhsa_next_free_sgpr 102
  .amdhsa_accum_offset 256
  .amdhsa_group_segment_fixed_size 0
  .amdhsa_kernarg_size 128
  .amdhsa_user_sgpr_count 2
  .amdhsa_user_sgpr_kernarg_segment_ptr 1
  .amdhsa_system_sgpr_workgroup_id_x 1
.end_amdhsa_kernel
```
